```python
import torch

def _softmax(x, axis=-1):
    return torch.softmax(x, dim=axis)
def _gelu(x):
    return torch.nn.functional.gelu(x, approximate="tanh")
def _silu(x):
    return torch.nn.functional.silu(x)
def _sigmoid(x):
    return torch.sigmoid(x)
def _layernorm(x, axis=-1, eps=1e-5):
    m = x.mean(dim=axis, keepdim=True)
    v = x.var(dim=axis, keepdim=True, unbiased=False)
    return (x - m) / torch.sqrt(v + eps)
def _scatter_add(tgt, idx, src, axis=0):
    return tgt.clone().index_add_(axis, idx, src)
def _segment_sum(src, seg, n):
    out = torch.zeros((n,) + src.shape[1:], dtype=src.dtype)
    return out.index_add_(0, seg, src)
def _pad(x, pw):
    flat = tuple(v for pair in reversed(pw) for v in pair)
    return torch.nn.functional.pad(x, flat)

kernel_name = 'sequential_preLN__spectral_gfnet__mixer_s_mlp__prompt'

def setup_inputs():

    _w = (lambda a: (lambda t: t.to(torch.bfloat16) if t.is_floating_point() else t)(torch.as_tensor(a)))
    def _A_setup():
        B, S, D = 1, 2048, 640
        Df = D // 2 + 1
        return {
            "x": _w((lambda *s: torch.randn(*s, dtype=torch.bfloat16) * 0.05)(B, S, D)),
            "w_r": _w((lambda *s: torch.randn(*s, dtype=torch.bfloat16) * 0.4)(S, Df) * 0.02),
            "w_i": _w((lambda *s: torch.randn(*s, dtype=torch.bfloat16) * 0.4)(S, Df) * 0.02),
        }
    _A_in = _A_setup()

    def _B_setup():
        B, S, D, F = 1, 2048, 640, 1728
        return {
            "x":  _w((lambda *s: torch.randn(*s, dtype=torch.bfloat16) * 0.05)(B, S, D)),
            "w1": _w((lambda *s: torch.randn(*s, dtype=torch.bfloat16) * 0.8)(D, D) * (D ** -0.5)),
            "w2": _w((lambda *s: torch.randn(*s, dtype=torch.bfloat16) * 0.8)(D, D) * (D ** -0.5)),
            "w3": _w((lambda *s: torch.randn(*s, dtype=torch.bfloat16) * 0.8)(D, F) * (D ** -0.5)),
            "w4": _w((lambda *s: torch.randn(*s, dtype=torch.bfloat16) * 0.8)(F, D) * (F ** -0.5)),
        }
    _B_in = _B_setup()

    return {
        "A_x": _A_in["x"],
        "A_w_r": _A_in["w_r"],
        "A_w_i": _A_in["w_i"],
        "B_x": _B_in["x"],
        "B_w1": _B_in["w1"],
        "B_w2": _B_in["w2"],
        "B_w3": _B_in["w3"],
        "B_w4": _B_in["w4"],
    }

def reference(A_x, A_w_r, A_w_i, B_x, B_w1, B_w2, B_w3, B_w4):
    def _A_ref(x, w_r, w_i):
        B, S, D = x.shape
        X = (lambda x, axes=(-2,-1): torch.fft.rfft2(x.float(), dim=axes))(x, axes=(-2, -1))
        W = w_r + 1j * w_i
        X = X * W
        y = (lambda x, s, axes=(-2,-1): torch.fft.irfft2(x, s=s, dim=axes).to(torch.bfloat16))(X, (S, D), axes=(-2, -1))
        return y

    def _B_ref(x, w1, w2, w3, w4):
        B, S, D = x.shape
        h = _gelu(_layernorm(x, axis=-1) @ w1)
        c = D // 4
        g0 = _pad(h[:, :, 0*c:1*c], ((0, 0), (1, 0), (0, 0)))[:, :S, :]
        g1 = _pad(h[:, :, 1*c:2*c], ((0, 0), (0, 1), (0, 0)))[:, 1:, :]
        g2 = _pad(h[:, :, 2*c:3*c], ((0, 0), (2, 0), (0, 0)))[:, :S, :]
        g3 = _pad(h[:, :, 3*c:   ], ((0, 0), (0, 2), (0, 0)))[:, 2:, :]
        hs = torch.concatenate([g0, g1, g2, g3], axis=-1) @ w2
        x1 = x + hs
        h2 = _gelu(_layernorm(x1, axis=-1) @ w3) @ w4
        return x1 + h2

    x = A_x
    h = x + _A_ref(_layernorm(x, axis=-1), A_w_r, A_w_i)
    h2 = h + _B_ref(_layernorm(h, axis=-1), B_w1, B_w2, B_w3, B_w4)
    return h2
```

```asm
; @launch kernel=k1_kernel grid=(982,1,1) block=(256,1,1) lds=16384
; @launch kernel=k2_kernel grid=(613,1,1) block=(256,1,1) lds=16896
; @launch kernel=kf_kernel grid=(256,1,1) block=(512,1,1) lds=163840
.amdgcn_target "amdgcn-amd-amdhsa--gfx950"
.text
.globl k1_kernel
.p2align 8
.type k1_kernel,@function
k1_kernel:
  s_cmp_ge_u32 s2, 256
  s_cbranch_scc1 .Lk1_kernel_other6
  s_load_dwordx2 s[4:5], s[0:1], 0
  s_load_dwordx2 s[16:17], s[0:1], 80
  v_lshrrev_b32 v1, 6, v0
  v_bfe_u32 v2, v0, 4, 2
  v_readfirstlane_b32 s20, v1
  v_and_b32 v1, 15, v0
  v_mul_u32_u24 v3, 320, v2
  v_lshl_add_u32 v3, v1, 2, v3
  s_and_b32 s40, s2, 7
  s_lshr_b32 s41, s2, 5
  s_lshl_b32 s41, s41, 3
  s_add_u32 s40, s40, s41
  s_bfe_u32 s41, s2, 0x20003
  s_lshl_b32 s3, s40, 2
  s_add_u32 s3, s3, s41
  s_mul_i32 s40, s40, 41472
  s_lshl_b32 s41, s41, 5
  s_add_u32 s40, s40, s41
  s_lshr_b32 s22, s3, 3
  s_and_b32 s23, s3, 7
  s_lshl_b32 s23, s23, 3
  s_lshl_b32 s24, s20, 1
  s_add_u32 s23, s23, s24
  s_lshl_b32 s23, s23, 5
  s_add_u32 s23, s23, s22
  s_mul_i32 s24, s23, 1280
  s_add_u32 s25, s24, 40960
  s_mov_b32 s6, 0x280000
  s_mov_b32 s7, 0x00020000
  s_waitcnt lgkmcnt(0)
  buffer_load_dword v6, v3, s[4:7], s24 offen offset:0
  buffer_load_dword v7, v3, s[4:7], s24 offen offset:64
  buffer_load_dword v8, v3, s[4:7], s24 offen offset:128
  buffer_load_dword v9, v3, s[4:7], s24 offen offset:192
  buffer_load_dword v10, v3, s[4:7], s24 offen offset:256
  buffer_load_dword v12, v3, s[4:7], s25 offen offset:0
  buffer_load_dword v13, v3, s[4:7], s25 offen offset:64
  buffer_load_dword v14, v3, s[4:7], s25 offen offset:128
  buffer_load_dword v15, v3, s[4:7], s25 offen offset:192
  buffer_load_dword v16, v3, s[4:7], s25 offen offset:256
  v_cvt_f32_u32 v4, v1
  v_cvt_f32_u32 v5, v2
  v_mul_f32 v5, v5, v4
  v_mul_f32 v84, 0x3e800000, v5
  v_mul_f32 v108, 0x3d4ccccd, v4
  v_add_f32 v85, v84, v108
  v_add_f32 v86, v85, v108
  v_add_f32 v87, v86, v108
  v_add_f32 v88, v87, v108
  v_cos_f32 v92, v84
  v_sin_f32 v100, v84
  v_cos_f32 v93, v85
  v_sin_f32 v101, v85
  v_cos_f32 v94, v86
  v_sin_f32 v102, v86
  v_cos_f32 v95, v87
  v_sin_f32 v103, v87
  v_cos_f32 v96, v88
  v_sin_f32 v104, v88
  v_cvt_pk_bf16_f32 v20, v92, v93
  v_cvt_pk_bf16_f32 v24, -v100, -v101
  v_cvt_pk_bf16_f32 v21, v94, v95
  v_cvt_pk_bf16_f32 v25, -v102, -v103
  v_cvt_pk_bf16_f32 v22, v96, v96
  v_cvt_pk_bf16_f32 v26, -v104, -v104
  v_mov_b32 v23, 0
  v_mov_b32 v27, 0
  v_mul_f32 v84, 0x3e800000, v5
  v_mul_f32 v108, 0x3d000000, v4
  v_add_f32 v85, v84, v108
  v_add_f32 v86, v85, v108
  v_add_f32 v87, v86, v108
  v_add_f32 v88, v87, v108
  v_add_f32 v89, v88, v108
  v_add_f32 v90, v89, v108
  v_add_f32 v91, v90, v108
  v_cos_f32 v92, v84
  v_sin_f32 v100, v84
  v_cos_f32 v93, v85
  v_sin_f32 v101, v85
  v_cos_f32 v94, v86
  v_sin_f32 v102, v86
  v_cos_f32 v95, v87
  v_sin_f32 v103, v87
  v_cos_f32 v96, v88
  v_sin_f32 v104, v88
  v_cos_f32 v97, v89
  v_sin_f32 v105, v89
  v_cos_f32 v98, v90
  v_sin_f32 v106, v90
  v_cos_f32 v99, v91
  v_sin_f32 v107, v91
  s_mov_b32 s44, 0x80008000
  s_mov_b32 s45, 0x80000000
  s_mov_b32 s46, 0x8000
  v_cvt_pk_bf16_f32 v28, v92, v93
  v_cvt_pk_bf16_f32 v32, v100, v101
  v_cvt_pk_bf16_f32 v29, v94, v95
  v_cvt_pk_bf16_f32 v33, v102, v103
  v_cvt_pk_bf16_f32 v30, v96, v97
  v_cvt_pk_bf16_f32 v34, v104, v105
  v_cvt_pk_bf16_f32 v31, v98, v99
  v_cvt_pk_bf16_f32 v35, v106, v107
  v_xor_b32 v36, s44, v32
  v_xor_b32 v40, s45, v28
  v_xor_b32 v44, s45, v32
  v_xor_b32 v48, s46, v28
  v_xor_b32 v37, s44, v33
  v_xor_b32 v41, s45, v29
  v_xor_b32 v45, s45, v33
  v_xor_b32 v49, s46, v29
  v_xor_b32 v38, s44, v34
  v_xor_b32 v42, s45, v30
  v_xor_b32 v46, s45, v34
  v_xor_b32 v50, s46, v30
  v_xor_b32 v39, s44, v35
  v_xor_b32 v43, s45, v31
  v_xor_b32 v47, s45, v35
  v_xor_b32 v51, s46, v31
  v_mul_f32 v84, 0x3c4ccccd, v5
  v_mul_f32 v108, 0x3acccccd, v4
  v_add_f32 v85, v84, v108
  v_add_f32 v86, v85, v108
  v_add_f32 v87, v86, v108
  v_add_f32 v88, v87, v108
  v_add_f32 v89, v88, v108
  v_add_f32 v90, v89, v108
  v_add_f32 v91, v90, v108
  v_cos_f32 v52, v84
  v_sin_f32 v56, v84
  v_cos_f32 v60, v85
  v_sin_f32 v64, v85
  v_cos_f32 v53, v86
  v_sin_f32 v57, v86
  v_cos_f32 v61, v87
  v_sin_f32 v65, v87
  v_cos_f32 v54, v88
  v_sin_f32 v58, v88
  v_cos_f32 v62, v89
  v_sin_f32 v66, v89
  v_cos_f32 v55, v90
  v_sin_f32 v59, v90
  v_cos_f32 v63, v91
  v_sin_f32 v67, v91
  s_mov_b32 s12, s16
  s_mov_b32 s13, s17
  s_mov_b32 s14, 0x288000
  s_mov_b32 s15, 0x00020000
  v_mul_u32_u24 v117, 80, v2
  v_add_u32 v117, v117, v1
  s_lshl_b32 s26, s20, 3
  v_mov_b32 v116, s26
  v_mad_u32_u24 v3, v117, 40, v116
  v_sub_u32 v117, 260, v117
  v_mad_u32_u24 v116, v117, 40, v116
  v_cmp_lt_u32 vcc, 10, v1
  v_mov_b32 v117, 13312
  s_nop 0
  v_cndmask_b32 v3, v3, v117, vcc
  v_cndmask_b32 v116, v116, v117, vcc
  v_mov_b32 v5, 0x35cccccd
  v_mov_b32 v117, 0x354ccccd
  v_cmp_eq_u32 vcc, 10, v1
  s_nop 1
  v_cndmask_b32 v5, v5, v117, vcc
  v_cmp_eq_u32 vcc, 0, v1
  s_nop 1
  v_cndmask_b32 v5, v5, v117, vcc
  v_mov_b32 v117, 0xb7800000
  v_cndmask_b32 v4, 0, v117, vcc
  s_mov_b32 s27, 0x3f803f80
  s_mov_b32 s28, 0x05040100
  s_mov_b32 s29, 0x07060302
  s_mov_b32 s30, 0xffff
  v_mov_b32 v71, 0
  v_mov_b32 v75, 0
  v_mov_b32 v79, 0
  v_mov_b32 v83, 0
  v_mov_b32 v118, 0
  v_mov_b32 v119, 0
  v_mov_b32 v120, 0
  v_mov_b32 v121, 0
  s_waitcnt vmcnt(8)
  v_perm_b32 v68, v7, v6, s28
  s_waitcnt vmcnt(6)
  v_perm_b32 v69, v9, v8, s28
  s_waitcnt vmcnt(5)
  v_and_b32 v70, s30, v10
  v_perm_b32 v72, v7, v6, s29
  v_perm_b32 v73, v9, v8, s29
  v_lshrrev_b32 v74, 16, v10
  s_waitcnt vmcnt(3)
  v_perm_b32 v76, v13, v12, s28
  s_waitcnt vmcnt(1)
  v_perm_b32 v77, v15, v14, s28
  s_waitcnt vmcnt(0)
  v_and_b32 v78, s30, v16
  v_perm_b32 v80, v13, v12, s29
  v_perm_b32 v81, v15, v14, s29
  v_lshrrev_b32 v82, 16, v16
  v_dot2_f32_bf16 v118, v6, s27, v118
  v_dot2_f32_bf16 v119, v6, v6, v119
  v_dot2_f32_bf16 v120, v12, s27, v120
  v_dot2_f32_bf16 v121, v12, v12, v121
  v_dot2_f32_bf16 v118, v7, s27, v118
  v_dot2_f32_bf16 v119, v7, v7, v119
  v_dot2_f32_bf16 v120, v13, s27, v120
  v_dot2_f32_bf16 v121, v13, v13, v121
  v_dot2_f32_bf16 v118, v8, s27, v118
  v_dot2_f32_bf16 v119, v8, v8, v119
  v_dot2_f32_bf16 v120, v14, s27, v120
  v_dot2_f32_bf16 v121, v14, v14, v121
  v_dot2_f32_bf16 v118, v9, s27, v118
  v_dot2_f32_bf16 v119, v9, v9, v119
  v_dot2_f32_bf16 v120, v15, s27, v120
  v_dot2_f32_bf16 v121, v15, v15, v121
  v_dot2_f32_bf16 v118, v10, s27, v118
  v_dot2_f32_bf16 v119, v10, v10, v119
  v_dot2_f32_bf16 v120, v16, s27, v120
  v_dot2_f32_bf16 v121, v16, v16, v121
  v_mfma_f32_16x16x32_bf16 v[84:87], v[68:71], v[20:23], 0
  v_mfma_f32_16x16x32_bf16 v[88:91], v[68:71], v[24:27], 0
  v_mfma_f32_16x16x32_bf16 v[92:95], v[72:75], v[20:23], 0
  v_mfma_f32_16x16x32_bf16 v[96:99], v[72:75], v[24:27], 0
  v_mfma_f32_16x16x32_bf16 v[100:103], v[76:79], v[20:23], 0
  v_mfma_f32_16x16x32_bf16 v[104:107], v[76:79], v[24:27], 0
  v_mfma_f32_16x16x32_bf16 v[108:111], v[80:83], v[20:23], 0
  v_mfma_f32_16x16x32_bf16 v[112:115], v[80:83], v[24:27], 0
  v_permlane32_swap_b32 v118, v119
  v_permlane32_swap_b32 v120, v121
  v_add_f32 v118, v118, v119
  v_add_f32 v120, v120, v121
  s_nop 1
  v_permlane16_swap_b32 v118, v120
  v_add_f32 v118, v118, v120
  s_nop 1
  v_add_f32_dpp v118, v118, v118 quad_perm:[1,0,3,2] row_mask:0xf bank_mask:0xf
  s_nop 1
  v_add_f32_dpp v118, v118, v118 quad_perm:[2,3,0,1] row_mask:0xf bank_mask:0xf
  s_nop 1
  v_add_f32_dpp v118, v118, v118 row_half_mirror row_mask:0xf bank_mask:0xf
  s_nop 1
  v_add_f32_dpp v118, v118, v118 row_mirror row_mask:0xf bank_mask:0xf
  v_mov_b32 v119, v118
  s_nop 1
  v_permlane32_swap_b32 v118, v119
  v_mul_f32 v118, 0x3acccccd, v118
  v_mul_f32 v119, 0x3acccccd, v119
  v_fma_f32 v119, -v118, v118, v119
  v_max_f32 v119, 0, v119
  v_cvt_pk_bf16_f32 v119, v119, v119
  v_lshlrev_b32 v119, 16, v119
  v_cvt_pk_bf16_f32 v118, v118, v118
  v_lshlrev_b32 v118, 16, v118
  v_add_f32 v119, 0x3727c5ac, v119
  v_cvt_pk_bf16_f32 v119, v119, v119
  v_lshlrev_b32 v119, 16, v119
  v_sqrt_f32 v119, v119
  s_nop 0
  v_cvt_pk_bf16_f32 v119, v119, v119
  v_lshlrev_b32 v119, 16, v119
  v_rcp_f32 v119, v119
  s_nop 0
  v_mul_f32 v118, v118, v119
  v_readlane_b32 s32, v119, 0
  v_readlane_b32 s34, v119, 16
  v_readlane_b32 s36, v118, 0
  v_readlane_b32 s37, v118, 16
  s_nop 0
  v_mul_f32 v20, s36, v4
  v_mul_f32 v24, s32, v5
  v_mul_f32 v22, s37, v4
  v_mul_f32 v26, s34, v5
  v_pk_fma_f32 v[84:85], v[84:85], v[24:25], v[20:21] op_sel_hi:[1,0,0]
  v_pk_mul_f32 v[88:89], v[88:89], v[24:25] op_sel_hi:[1,0]
  v_pk_fma_f32 v[86:87], v[86:87], v[24:25], v[20:21] op_sel_hi:[1,0,0]
  v_pk_mul_f32 v[90:91], v[90:91], v[24:25] op_sel_hi:[1,0]
  v_pk_mul_f32 v[6:7], v[88:89], v[56:57]
  v_pk_mul_f32 v[10:11], v[84:85], v[56:57]
  v_pk_mul_f32 v[8:9], v[90:91], v[58:59]
  v_pk_mul_f32 v[12:13], v[86:87], v[58:59]
  v_pk_fma_f32 v[84:85], v[84:85], v[52:53], v[6:7]
  v_pk_fma_f32 v[88:89], v[88:89], v[52:53], v[10:11] neg_lo:[0,0,1] neg_hi:[0,0,1]
  v_pk_fma_f32 v[86:87], v[86:87], v[54:55], v[8:9]
  v_pk_fma_f32 v[90:91], v[90:91], v[54:55], v[12:13] neg_lo:[0,0,1] neg_hi:[0,0,1]
  v_pk_fma_f32 v[92:93], v[92:93], v[24:25], v[20:21] op_sel_hi:[1,0,0]
  v_pk_mul_f32 v[96:97], v[96:97], v[24:25] op_sel_hi:[1,0]
  v_pk_fma_f32 v[94:95], v[94:95], v[24:25], v[20:21] op_sel_hi:[1,0,0]
  v_pk_mul_f32 v[98:99], v[98:99], v[24:25] op_sel_hi:[1,0]
  v_pk_mul_f32 v[6:7], v[96:97], v[64:65]
  v_pk_mul_f32 v[10:11], v[92:93], v[64:65]
  v_pk_mul_f32 v[8:9], v[98:99], v[66:67]
  v_pk_mul_f32 v[12:13], v[94:95], v[66:67]
  v_pk_fma_f32 v[92:93], v[92:93], v[60:61], v[6:7]
  v_pk_fma_f32 v[96:97], v[96:97], v[60:61], v[10:11] neg_lo:[0,0,1] neg_hi:[0,0,1]
  v_pk_fma_f32 v[94:95], v[94:95], v[62:63], v[8:9]
  v_pk_fma_f32 v[98:99], v[98:99], v[62:63], v[12:13] neg_lo:[0,0,1] neg_hi:[0,0,1]
  v_cvt_pk_bf16_f32 v68, v84, v92
  v_cvt_pk_bf16_f32 v72, v88, v96
  v_cvt_pk_bf16_f32 v69, v85, v93
  v_cvt_pk_bf16_f32 v73, v89, v97
  v_cvt_pk_bf16_f32 v70, v86, v94
  v_cvt_pk_bf16_f32 v74, v90, v98
  v_cvt_pk_bf16_f32 v71, v87, v95
  v_cvt_pk_bf16_f32 v75, v91, v99
  s_nop 0
  v_mfma_f32_16x16x32_bf16 v[84:87], v[28:31], v[68:71], 0
  v_mfma_f32_16x16x32_bf16 v[88:91], v[36:39], v[68:71], 0
  v_mfma_f32_16x16x32_bf16 v[92:95], v[40:43], v[68:71], 0
  v_mfma_f32_16x16x32_bf16 v[96:99], v[44:47], v[68:71], 0
  v_mfma_f32_16x16x32_bf16 v[84:87], v[32:35], v[72:75], v[84:87]
  v_mfma_f32_16x16x32_bf16 v[88:91], v[28:31], v[72:75], v[88:91]
  v_mfma_f32_16x16x32_bf16 v[92:95], v[44:47], v[72:75], v[92:95]
  v_mfma_f32_16x16x32_bf16 v[96:99], v[48:51], v[72:75], v[96:99]
  v_pk_fma_f32 v[100:101], v[100:101], v[26:27], v[22:23] op_sel_hi:[1,0,0]
  v_pk_mul_f32 v[104:105], v[104:105], v[26:27] op_sel_hi:[1,0]
  v_pk_fma_f32 v[102:103], v[102:103], v[26:27], v[22:23] op_sel_hi:[1,0,0]
  v_pk_mul_f32 v[106:107], v[106:107], v[26:27] op_sel_hi:[1,0]
  v_pk_mul_f32 v[6:7], v[104:105], v[56:57]
  v_pk_mul_f32 v[10:11], v[100:101], v[56:57]
  v_pk_mul_f32 v[8:9], v[106:107], v[58:59]
  v_pk_mul_f32 v[12:13], v[102:103], v[58:59]
  v_pk_fma_f32 v[100:101], v[100:101], v[52:53], v[6:7]
  v_pk_fma_f32 v[104:105], v[104:105], v[52:53], v[10:11] neg_lo:[0,0,1] neg_hi:[0,0,1]
  v_pk_fma_f32 v[102:103], v[102:103], v[54:55], v[8:9]
  v_pk_fma_f32 v[106:107], v[106:107], v[54:55], v[12:13] neg_lo:[0,0,1] neg_hi:[0,0,1]
  v_pk_fma_f32 v[108:109], v[108:109], v[26:27], v[22:23] op_sel_hi:[1,0,0]
  v_pk_mul_f32 v[112:113], v[112:113], v[26:27] op_sel_hi:[1,0]
  v_pk_fma_f32 v[110:111], v[110:111], v[26:27], v[22:23] op_sel_hi:[1,0,0]
  v_pk_mul_f32 v[114:115], v[114:115], v[26:27] op_sel_hi:[1,0]
  v_pk_mul_f32 v[6:7], v[112:113], v[64:65]
  v_pk_mul_f32 v[10:11], v[108:109], v[64:65]
  v_pk_mul_f32 v[8:9], v[114:115], v[66:67]
  v_pk_mul_f32 v[12:13], v[110:111], v[66:67]
  v_pk_fma_f32 v[108:109], v[108:109], v[60:61], v[6:7]
  v_pk_fma_f32 v[112:113], v[112:113], v[60:61], v[10:11] neg_lo:[0,0,1] neg_hi:[0,0,1]
  v_pk_fma_f32 v[110:111], v[110:111], v[62:63], v[8:9]
  v_pk_fma_f32 v[114:115], v[114:115], v[62:63], v[12:13] neg_lo:[0,0,1] neg_hi:[0,0,1]
  v_cvt_pk_bf16_f32 v76, v100, v108
  v_cvt_pk_bf16_f32 v80, v104, v112
  v_cvt_pk_bf16_f32 v77, v101, v109
  v_cvt_pk_bf16_f32 v81, v105, v113
  v_cvt_pk_bf16_f32 v78, v102, v110
  v_cvt_pk_bf16_f32 v82, v106, v114
  v_cvt_pk_bf16_f32 v79, v103, v111
  v_cvt_pk_bf16_f32 v83, v107, v115
  s_nop 0
  v_mfma_f32_16x16x32_bf16 v[100:103], v[28:31], v[76:79], 0
  v_mfma_f32_16x16x32_bf16 v[104:107], v[36:39], v[76:79], 0
  v_mfma_f32_16x16x32_bf16 v[108:111], v[40:43], v[76:79], 0
  v_mfma_f32_16x16x32_bf16 v[112:115], v[44:47], v[76:79], 0
  v_mfma_f32_16x16x32_bf16 v[100:103], v[32:35], v[80:83], v[100:103]
  v_mfma_f32_16x16x32_bf16 v[104:107], v[28:31], v[80:83], v[104:107]
  v_mfma_f32_16x16x32_bf16 v[108:111], v[44:47], v[80:83], v[108:111]
  v_mfma_f32_16x16x32_bf16 v[112:115], v[48:51], v[80:83], v[112:115]
  v_and_b32 v117, 1, v0
  v_mul_u32_u24 v118, 20, v0
  v_lshlrev_b32 v117, 2, v117
  v_sub_u32 v118, v118, v117
  v_lshrrev_b32 v119, 1, v0
  v_lshlrev_b32 v119, 7, v119
  v_lshl_add_u32 v119, v117, 2, v119
  v_cmp_gt_u32 vcc, 130, v0
  v_mov_b32 v117, 0x40000000
  s_nop 0
  v_cndmask_b32 v120, v117, v119, vcc
  s_add_u32 s41, s40, 16384
  s_add_u32 s42, s40, 32768
  v_cvt_pk_bf16_f32 v52, v84, v88
  v_cvt_pk_bf16_f32 v53, v100, v104
  ds_write_b64 v3, v[52:53] offset:0
  v_cvt_pk_bf16_f32 v54, v85, v89
  v_cvt_pk_bf16_f32 v55, v101, v105
  ds_write_b64 v3, v[54:55] offset:800
  v_cvt_pk_bf16_f32 v56, v86, v90
  v_cvt_pk_bf16_f32 v57, v102, v106
  ds_write_b64 v3, v[56:57] offset:1600
  v_cvt_pk_bf16_f32 v58, v87, v91
  v_cvt_pk_bf16_f32 v59, v103, v107
  ds_write_b64 v3, v[58:59] offset:2400
  v_cvt_pk_bf16_f32 v60, v92, v96
  v_cvt_pk_bf16_f32 v61, v108, v112
  ds_write_b64 v116, v[60:61] offset:2400
  v_cvt_pk_bf16_f32 v62, v93, v97
  v_cvt_pk_bf16_f32 v63, v109, v113
  ds_write_b64 v116, v[62:63] offset:1600
  v_cvt_pk_bf16_f32 v64, v94, v98
  v_cvt_pk_bf16_f32 v65, v110, v114
  ds_write_b64 v116, v[64:65] offset:800
  v_cvt_pk_bf16_f32 v66, v95, v99
  v_cvt_pk_bf16_f32 v67, v111, v115
  ds_write_b64 v116, v[66:67] offset:0
  s_waitcnt lgkmcnt(0)
  s_barrier
  ds_read2_b64 v[20:23], v118 offset0:0 offset1:1
  v_add_u32 v118, 5120, v118
  ds_read2_b64 v[24:27], v118 offset0:0 offset1:1
  v_add_u32 v118, 5120, v118
  ds_read2_b64 v[28:31], v118 offset0:0 offset1:1
  s_waitcnt lgkmcnt(2)
  buffer_store_dwordx4 v[20:23], v119, s[12:15], s40 offen
  s_waitcnt lgkmcnt(1)
  buffer_store_dwordx4 v[24:27], v119, s[12:15], s41 offen
  s_waitcnt lgkmcnt(0)
  buffer_store_dwordx4 v[28:31], v120, s[12:15], s42 offen
  s_endpgm
.Lk1_kernel_other6:
  s_cmp_ge_u32 s2, 512
  s_cbranch_scc1 .Lk1_kernel_other7
  s_load_dwordx2 s[4:5], s[0:1], 8
  s_load_dwordx2 s[8:9], s[0:1], 16
  s_load_dwordx2 s[16:17], s[0:1], 80
  s_sub_u32 s2, s2, 256
  s_and_b32 s40, s2, 7
  s_lshr_b32 s41, s2, 5
  s_lshl_b32 s41, s41, 3
  s_add_u32 s40, s40, s41
  s_bfe_u32 s41, s2, 0x20003
  s_lshl_b32 s3, s40, 2
  s_add_u32 s3, s3, s41
  s_mul_i32 s40, s40, 41472
  s_lshl_b32 s41, s41, 5
  s_add_u32 s40, s40, s41
  s_add_u32 s2, s2, 256
  v_lshrrev_b32 v10, 6, v0
  v_and_b32 v9, 63, v0
  v_readfirstlane_b32 s19, v10
  v_mov_b32 v11, 0x40000000
  v_lshlrev_b32 v12, 4, v9
  v_cmp_gt_u32 vcc, 41, v9
  s_nop 1
  v_cndmask_b32 v12, v11, v12, vcc
  s_lshr_b32 s20, s3, 2
  s_and_b32 s21, s3, 3
  s_lshl_b32 s21, s21, 2
  s_add_u32 s21, s21, s19
  s_lshl_b32 s21, s21, 7
  s_add_u32 s21, s20, s21
  s_mul_i32 s21, s21, 642
  s_and_b32 s23, s21, 15
  s_andn2_b32 s21, s21, 15
  s_add_u32 s22, s21, 41088
  s_lshl_b32 s25, s19, 11
  s_mov_b32 s6, 0x141000
  s_mov_b32 s7, 0x00020000
  s_mov_b32 s10, 0x141000
  s_mov_b32 s11, 0x00020000
  s_add_u32 m0, s25, 0
  s_waitcnt lgkmcnt(0)
  buffer_load_dwordx4 v12, s[4:7], s21 offen lds
  s_add_u32 m0, s25, 1024
  s_nop 0
  buffer_load_dwordx4 v12, s[4:7], s22 offen lds
  s_add_u32 m0, s25, 8192
  s_nop 0
  buffer_load_dwordx4 v12, s[8:11], s21 offen lds
  s_add_u32 m0, s25, 9216
  s_nop 0
  buffer_load_dwordx4 v12, s[8:11], s22 offen lds
  v_add_u32 v9, 0, v0
  v_and_b32 v10, 1, v0
  v_mul_u32_u24 v10, 4095, v10
  v_add3_u32 v2, v9, v10, s23
  v_lshlrev_b32 v6, 6, v9
  v_and_b32 v10, 48, v10
  v_sub_u32 v6, v6, v10
  v_add_u32 v9, 256, v0
  v_and_b32 v10, 1, v0
  v_mul_u32_u24 v10, 4095, v10
  v_add3_u32 v3, v9, v10, s23
  v_lshlrev_b32 v7, 6, v9
  v_and_b32 v10, 48, v10
  v_sub_u32 v7, v7, v10
  v_add_u32 v9, 512, v0
  v_and_b32 v10, 1, v0
  v_mul_u32_u24 v10, 4095, v10
  v_add3_u32 v4, v9, v10, s23
  v_lshlrev_b32 v8, 6, v9
  v_and_b32 v10, 48, v10
  v_sub_u32 v8, v8, v10
  v_cmp_gt_u32 vcc, 642, v9
  s_nop 1
  v_cndmask_b32 v8, v11, v8, vcc
  s_add_u32 s12, s16, 0x288000
  s_addc_u32 s13, s17, 0
  s_mov_b32 s14, 0x288000
  s_mov_b32 s15, 0x00020000
  s_waitcnt vmcnt(0)
  s_barrier
  ds_read_u16 v16, v2 offset:0
  ds_read_u16 v28, v2 offset:8192
  ds_read_u16 v17, v2 offset:1024
  ds_read_u16 v29, v2 offset:9216
  ds_read_u16 v18, v2 offset:2048
  ds_read_u16 v30, v2 offset:10240
  ds_read_u16 v19, v2 offset:3072
  ds_read_u16 v31, v2 offset:11264
  ds_read_u16 v20, v3 offset:0
  ds_read_u16 v32, v3 offset:8192
  ds_read_u16 v21, v3 offset:1024
  ds_read_u16 v33, v3 offset:9216
  ds_read_u16 v22, v3 offset:2048
  ds_read_u16 v34, v3 offset:10240
  ds_read_u16 v23, v3 offset:3072
  ds_read_u16 v35, v3 offset:11264
  ds_read_u16 v24, v4 offset:0
  ds_read_u16 v36, v4 offset:8192
  ds_read_u16 v25, v4 offset:1024
  ds_read_u16 v37, v4 offset:9216
  ds_read_u16 v26, v4 offset:2048
  ds_read_u16 v38, v4 offset:10240
  ds_read_u16 v27, v4 offset:3072
  ds_read_u16 v39, v4 offset:11264
  s_waitcnt lgkmcnt(15)
  v_lshl_or_b32 v16, v28, 16, v16
  v_lshl_or_b32 v17, v29, 16, v17
  v_lshl_or_b32 v18, v30, 16, v18
  v_lshl_or_b32 v19, v31, 16, v19
  buffer_store_dwordx4 v[16:19], v6, s[12:15], s40 offen
  s_waitcnt lgkmcnt(14)
  v_lshl_or_b32 v20, v32, 16, v20
  s_waitcnt lgkmcnt(12)
  v_lshl_or_b32 v21, v33, 16, v21
  s_waitcnt lgkmcnt(10)
  v_lshl_or_b32 v22, v34, 16, v22
  s_waitcnt lgkmcnt(8)
  v_lshl_or_b32 v23, v35, 16, v23
  buffer_store_dwordx4 v[20:23], v7, s[12:15], s40 offen
  s_waitcnt lgkmcnt(6)
  v_lshl_or_b32 v24, v36, 16, v24
  s_waitcnt lgkmcnt(4)
  v_lshl_or_b32 v25, v37, 16, v25
  s_waitcnt lgkmcnt(2)
  v_lshl_or_b32 v26, v38, 16, v26
  s_waitcnt lgkmcnt(0)
  v_lshl_or_b32 v27, v39, 16, v27
  buffer_store_dwordx4 v[24:27], v8, s[12:15], s40 offen
  s_endpgm
.Lk1_kernel_other7:
  s_cmp_ge_u32 s2, 612
  s_cbranch_scc1 .Lk1_kernel_other8
  s_load_dwordx2 s[4:5], s[0:1], 32
  s_load_dwordx2 s[16:17], s[0:1], 80
  s_sub_u32 s3, s2, 512
  v_lshrrev_b32 v1, 6, v0
  v_and_b32 v3, 63, v0
  v_readfirstlane_b32 s20, v1
  v_lshrrev_b32 v4, 2, v3
  v_mul_u32_u24 v4, 1280, v4
  v_and_b32 v1, 3, v0
  v_lshl_add_u32 v4, v1, 4, v4
  s_mov_b32 s19, s20
  s_mul_i32 s22, s3, 3277
  s_lshr_b32 s22, s22, 16
  s_mul_i32 s21, s22, 20
  s_sub_u32 s3, s3, s21
  s_lshl_b32 s22, s22, 2
  s_add_u32 s19, s19, s22
  s_mul_i32 s21, s19, 1
  s_mul_i32 s24, s21, 40960
  s_lshl_b32 s25, s3, 6
  s_add_u32 s24, s24, s25
  s_mov_b32 s6, 0xc8000
  s_mov_b32 s7, 0x00020000
  s_waitcnt lgkmcnt(0)
  buffer_load_dwordx4 v[8:11], v4, s[4:7], s24 offen
  s_add_u32 s24, s24, 20480
  buffer_load_dwordx4 v[12:15], v4, s[4:7], s24 offen
  s_mul_i32 s22, s3, 13108
  s_lshr_b32 s22, s22, 16
  s_mul_i32 s23, s22, 5
  s_sub_u32 s23, s3, s23
  s_mul_i32 s26, s22, 200
  s_lshl_b32 s30, s23, 1
  s_add_u32 s26, s26, s30
  s_add_u32 s27, s26, 1
  s_mul_i32 s28, s22, 10
  s_lshl_b32 s30, s23, 1
  s_add_u32 s28, s28, s30
  s_add_u32 s29, s28, 1
  s_mul_i32 s30, s21, 10
  s_add_u32 s26, s26, s30
  s_add_u32 s27, s27, s30
  s_lshl_b32 s26, s26, 10
  s_lshl_b32 s27, s27, 10
  s_add_u32 s12, s16, 0x1618000
  s_addc_u32 s13, s17, 0
  s_mov_b32 s14, 0xc8000
  s_mov_b32 s15, 0x00020000
  s_cmp_eq_u32 s23, 4
  s_mov_b32 s32, 0x05040100
  s_mov_b32 s33, 0x07060302
  s_cselect_b32 s34, 3, 4
  s_cselect_b32 s35, 32, 8
  v_lshlrev_b32 v3, 4, v3
  s_lshl_b32 s36, s20, 12
  v_add_u32 v5, s36, v3
  v_bfe_u32 v2, v0, 4, 2
  v_bfe_u32 v6, v0, 2, 2
  v_lshl_add_u32 v6, v2, 3, v6
  v_lshlrev_b32 v6, 6, v6
  v_lshlrev_b32 v1, s34, v1
  v_add3_u32 v6, v6, v1, s36
  v_add_u32 v4, s35, v6
  s_cmp_eq_u32 s23, 4
  s_cbranch_scc1 .Lk1_kernel_hal10
  s_waitcnt vmcnt(1)
  v_perm_b32 v24, v9, v8, s32
  v_perm_b32 v25, v11, v10, s32
  v_perm_b32 v26, v9, v8, s33
  v_perm_b32 v27, v11, v10, s33
  s_waitcnt vmcnt(0)
  v_perm_b32 v28, v13, v12, s32
  v_perm_b32 v29, v15, v14, s32
  v_perm_b32 v30, v13, v12, s33
  v_perm_b32 v31, v15, v14, s33
  ds_write_b128 v5, v[24:27] offset:0
  ds_write_b128 v5, v[28:31] offset:1024
  ds_read_b64_tr_b16 v[16:17], v6 offset:0
  ds_read_b64_tr_b16 v[18:19], v6 offset:256
  ds_read_b64_tr_b16 v[20:21], v4 offset:0
  ds_read_b64_tr_b16 v[22:23], v4 offset:256
  s_waitcnt lgkmcnt(2)
  buffer_store_dwordx4 v[16:19], v3, s[12:15], s26 offen
  s_waitcnt lgkmcnt(0)
  buffer_store_dwordx4 v[20:23], v3, s[12:15], s27 offen
  s_endpgm
.Lk1_kernel_hal10:
  s_waitcnt vmcnt(1)
  ds_write_b128 v5, v[8:11] offset:0
  s_waitcnt vmcnt(0)
  ds_write_b128 v5, v[12:15] offset:1024
  ds_read_b64_tr_b16 v[16:17], v6 offset:0
  ds_read_b64_tr_b16 v[18:19], v6 offset:256
  ds_read_b64_tr_b16 v[20:21], v4 offset:0
  ds_read_b64_tr_b16 v[22:23], v4 offset:256
  s_waitcnt lgkmcnt(2)
  buffer_store_dwordx4 v[16:19], v3, s[12:15], s26 offen
  s_waitcnt lgkmcnt(0)
  buffer_store_dwordx4 v[20:23], v3, s[12:15], s27 offen
.Lk1_kernel_pdone9:
  s_endpgm
.Lk1_kernel_other8:
  s_cmp_ge_u32 s2, 882
  s_cbranch_scc1 .Lk1_kernel_other12
  s_load_dwordx2 s[4:5], s[0:1], 48
  s_load_dwordx2 s[16:17], s[0:1], 80
  s_sub_u32 s3, s2, 612
  v_lshrrev_b32 v1, 6, v0
  v_and_b32 v3, 63, v0
  v_readfirstlane_b32 s20, v1
  v_lshrrev_b32 v4, 2, v3
  v_mul_u32_u24 v4, 3456, v4
  v_and_b32 v1, 3, v0
  v_lshl_add_u32 v4, v1, 4, v4
  s_mov_b32 s19, s20
  s_mul_i32 s22, s3, 1214
  s_lshr_b32 s22, s22, 16
  s_mul_i32 s21, s22, 54
  s_sub_u32 s3, s3, s21
  s_lshl_b32 s22, s22, 2
  s_add_u32 s19, s19, s22
  s_mul_i32 s21, s19, 1
  s_mul_i32 s24, s21, 110592
  s_lshl_b32 s25, s3, 6
  s_add_u32 s24, s24, s25
  s_mov_b32 s6, 0x21c000
  s_mov_b32 s7, 0x00020000
  s_waitcnt lgkmcnt(0)
  buffer_load_dwordx4 v[8:11], v4, s[4:7], s24 offen
  s_add_u32 s24, s24, 55296
  buffer_load_dwordx4 v[12:15], v4, s[4:7], s24 offen
  s_mul_i32 s22, s3, 9363
  s_lshr_b32 s22, s22, 16
  s_mul_i32 s23, s22, 7
  s_sub_u32 s23, s3, s23
  s_mul_i32 s26, s22, 280
  s_lshl_b32 s30, s23, 1
  s_add_u32 s26, s26, s30
  s_cmp_gt_u32 s23, 3
  s_cselect_b32 s30, 132, 0
  s_add_u32 s26, s26, s30
  s_cmp_eq_u32 s23, 3
  s_cselect_b32 s30, 140, 1
  s_add_u32 s27, s26, s30
  s_mul_i32 s30, s21, 7
  s_add_u32 s26, s26, s30
  s_add_u32 s27, s27, s30
  s_lshl_b32 s26, s26, 10
  s_lshl_b32 s27, s27, 10
  s_add_u32 s12, s16, 0x17a8000
  s_addc_u32 s13, s17, 0
  s_mov_b32 s14, 0x230000
  s_mov_b32 s15, 0x00020000
  s_cmp_eq_u32 s23, 3
  s_mov_b32 s32, 0x05040100
  s_mov_b32 s33, 0x07060302
  s_cselect_b32 s34, 3, 4
  s_cselect_b32 s35, 32, 8
  v_lshlrev_b32 v3, 4, v3
  s_lshl_b32 s36, s20, 12
  v_add_u32 v5, s36, v3
  v_bfe_u32 v2, v0, 4, 2
  v_bfe_u32 v6, v0, 2, 2
  v_lshl_add_u32 v6, v2, 3, v6
  v_lshlrev_b32 v6, 6, v6
  v_lshlrev_b32 v1, s34, v1
  v_add3_u32 v6, v6, v1, s36
  v_add_u32 v4, s35, v6
  s_cmp_eq_u32 s23, 3
  s_cbranch_scc1 .Lk1_kernel_hal14
  s_waitcnt vmcnt(1)
  v_perm_b32 v24, v9, v8, s32
  v_perm_b32 v25, v11, v10, s32
  v_perm_b32 v26, v9, v8, s33
  v_perm_b32 v27, v11, v10, s33
  s_waitcnt vmcnt(0)
  v_perm_b32 v28, v13, v12, s32
  v_perm_b32 v29, v15, v14, s32
  v_perm_b32 v30, v13, v12, s33
  v_perm_b32 v31, v15, v14, s33
  ds_write_b128 v5, v[24:27] offset:0
  ds_write_b128 v5, v[28:31] offset:1024
  ds_read_b64_tr_b16 v[16:17], v6 offset:0
  ds_read_b64_tr_b16 v[18:19], v6 offset:256
  ds_read_b64_tr_b16 v[20:21], v4 offset:0
  ds_read_b64_tr_b16 v[22:23], v4 offset:256
  s_waitcnt lgkmcnt(2)
  buffer_store_dwordx4 v[16:19], v3, s[12:15], s26 offen
  s_waitcnt lgkmcnt(0)
  buffer_store_dwordx4 v[20:23], v3, s[12:15], s27 offen
  s_endpgm
.Lk1_kernel_hal14:
  s_waitcnt vmcnt(1)
  ds_write_b128 v5, v[8:11] offset:0
  s_waitcnt vmcnt(0)
  ds_write_b128 v5, v[12:15] offset:1024
  ds_read_b64_tr_b16 v[16:17], v6 offset:0
  ds_read_b64_tr_b16 v[18:19], v6 offset:256
  ds_read_b64_tr_b16 v[20:21], v4 offset:0
  ds_read_b64_tr_b16 v[22:23], v4 offset:256
  s_waitcnt lgkmcnt(2)
  buffer_store_dwordx4 v[16:19], v3, s[12:15], s26 offen
  s_waitcnt lgkmcnt(0)
  buffer_store_dwordx4 v[20:23], v3, s[12:15], s27 offen
.Lk1_kernel_pdone13:
  s_endpgm
.Lk1_kernel_other12:
  s_cmp_ge_u32 s2, 982
  s_cbranch_scc1 .Lk1_kernel_other16
  s_load_dwordx2 s[4:5], s[0:1], 40
  s_load_dwordx2 s[16:17], s[0:1], 80
  s_sub_u32 s3, s2, 882
  v_lshrrev_b32 v1, 6, v0
  v_and_b32 v3, 63, v0
  v_readfirstlane_b32 s20, v1
  v_lshrrev_b32 v4, 2, v3
  v_mul_u32_u24 v4, 1280, v4
  v_and_b32 v1, 3, v0
  v_lshl_add_u32 v4, v1, 4, v4
  s_mov_b32 s19, s20
  s_mul_i32 s22, s3, 3277
  s_lshr_b32 s22, s22, 16
  s_mul_i32 s21, s22, 20
  s_sub_u32 s3, s3, s21
  s_lshl_b32 s22, s22, 2
  s_add_u32 s19, s19, s22
  s_mul_i32 s21, s19, 1
  s_mul_i32 s24, s21, 40960
  s_lshl_b32 s25, s3, 6
  s_add_u32 s24, s24, s25
  s_mov_b32 s6, 0xc8000
  s_mov_b32 s7, 0x00020000
  s_waitcnt lgkmcnt(0)
  buffer_load_dwordx4 v[8:11], v4, s[4:7], s24 offen
  s_add_u32 s24, s24, 20480
  buffer_load_dwordx4 v[12:15], v4, s[4:7], s24 offen
  s_mul_i32 s22, s3, 13108
  s_lshr_b32 s22, s22, 16
  s_mul_i32 s23, s22, 5
  s_sub_u32 s23, s3, s23
  s_mul_i32 s26, s22, 200
  s_lshl_b32 s30, s23, 1
  s_add_u32 s26, s26, s30
  s_cmp_gt_u32 s23, 2
  s_cselect_b32 s30, 94, 0
  s_add_u32 s26, s26, s30
  s_cmp_eq_u32 s23, 2
  s_cselect_b32 s30, 100, 1
  s_add_u32 s27, s26, s30
  s_mul_i32 s30, s21, 5
  s_add_u32 s26, s26, s30
  s_add_u32 s27, s27, s30
  s_lshl_b32 s26, s26, 10
  s_lshl_b32 s27, s27, 10
  s_add_u32 s12, s16, 0x16e0000
  s_addc_u32 s13, s17, 0
  s_mov_b32 s14, 0xc8000
  s_mov_b32 s15, 0x00020000
  s_cmp_eq_u32 s23, 2
  s_mov_b32 s32, 0x05040100
  s_mov_b32 s33, 0x07060302
  s_cselect_b32 s34, 3, 4
  s_cselect_b32 s35, 32, 8
  v_lshlrev_b32 v3, 4, v3
  s_lshl_b32 s36, s20, 12
  v_add_u32 v5, s36, v3
  v_bfe_u32 v2, v0, 4, 2
  v_bfe_u32 v6, v0, 2, 2
  v_lshl_add_u32 v6, v2, 3, v6
  v_lshlrev_b32 v6, 6, v6
  v_lshlrev_b32 v1, s34, v1
  v_add3_u32 v6, v6, v1, s36
  v_add_u32 v4, s35, v6
  s_cmp_eq_u32 s23, 2
  s_cbranch_scc1 .Lk1_kernel_hal18
  s_waitcnt vmcnt(1)
  v_perm_b32 v24, v9, v8, s32
  v_perm_b32 v25, v11, v10, s32
  v_perm_b32 v26, v9, v8, s33
  v_perm_b32 v27, v11, v10, s33
  s_waitcnt vmcnt(0)
  v_perm_b32 v28, v13, v12, s32
  v_perm_b32 v29, v15, v14, s32
  v_perm_b32 v30, v13, v12, s33
  v_perm_b32 v31, v15, v14, s33
  ds_write_b128 v5, v[24:27] offset:0
  ds_write_b128 v5, v[28:31] offset:1024
  ds_read_b64_tr_b16 v[16:17], v6 offset:0
  ds_read_b64_tr_b16 v[18:19], v6 offset:256
  ds_read_b64_tr_b16 v[20:21], v4 offset:0
  ds_read_b64_tr_b16 v[22:23], v4 offset:256
  s_waitcnt lgkmcnt(2)
  buffer_store_dwordx4 v[16:19], v3, s[12:15], s26 offen
  s_waitcnt lgkmcnt(0)
  buffer_store_dwordx4 v[20:23], v3, s[12:15], s27 offen
  s_endpgm
.Lk1_kernel_hal18:
  s_waitcnt vmcnt(1)
  ds_write_b128 v5, v[8:11] offset:0
  s_waitcnt vmcnt(0)
  ds_write_b128 v5, v[12:15] offset:1024
  ds_read_b64_tr_b16 v[16:17], v6 offset:0
  ds_read_b64_tr_b16 v[18:19], v6 offset:256
  ds_read_b64_tr_b16 v[20:21], v4 offset:0
  ds_read_b64_tr_b16 v[22:23], v4 offset:256
  s_waitcnt lgkmcnt(2)
  buffer_store_dwordx4 v[16:19], v3, s[12:15], s26 offen
  s_waitcnt lgkmcnt(0)
  buffer_store_dwordx4 v[20:23], v3, s[12:15], s27 offen
.Lk1_kernel_pdone17:
  s_endpgm
.Lk1_kernel_other16:
  s_endpgm

.globl k2_kernel
.p2align 8
.type k2_kernel,@function
k2_kernel:
  s_cmp_ge_u32 s2, 321
  s_cbranch_scc1 .Lk2_kernel_other5
  s_load_dwordx2 s[16:17], s[0:1], 80
  s_mov_b32 s20, s2
  v_and_b32 v1, 63, v0
  v_lshrrev_b32 v2, 6, v0
  v_lshlrev_b32 v4, 4, v1
  v_readfirstlane_b32 s21, v2
  v_and_b32 v2, 15, v0
  v_lshrrev_b32 v3, 4, v1
  v_mul_u32_u24 v7, 41472, v2
  v_lshlrev_b32 v6, 1, v7
  v_lshl_add_u32 v7, v3, 4, v7
  v_lshl_add_u32 v6, v3, 4, v6
  s_lshl_b32 s22, s20, 7
  s_lshr_b32 s23, s21, 1
  s_lshl_b32 s23, s23, 5
  s_and_b32 s24, s21, 1
  s_add_u32 s23, s23, s24
  s_mul_i32 s23, s23, 41472
  s_add_u32 s23, s23, s22
  s_add_u32 s24, s23, 64
  s_lshl_b32 s22, s20, 7
  s_mul_i32 s25, s21, 663552
  s_add_u32 s25, s25, s22
  s_lshl_b32 s27, s21, 11
  s_add_u32 s26, s25, 64
  s_waitcnt lgkmcnt(0)
  s_mov_b32 s4, s16
  s_mov_b32 s5, s17
  s_mov_b32 s6, 0x288000
  s_mov_b32 s7, 0x00020000
  s_add_u32 s12, s16, 0x288000
  s_addc_u32 s13, s17, 0
  s_mov_b32 s14, 0x288000
  s_mov_b32 s15, 0x00020000
  s_mov_b32 m0, s27
  s_nop 0
  buffer_load_dwordx4 v6, s[4:7], s23 offen lds
  s_add_u32 m0, s27, 1024
  s_nop 0
  buffer_load_dwordx4 v6, s[4:7], s24 offen lds
  buffer_load_dwordx4 v[88:91], v7, s[12:15], s25 offen
  buffer_load_dwordx4 v[92:95], v7, s[12:15], s26 offen
  s_lshl_b32 s28, s21, 4
  v_add_u32 v112, s28, v2
  v_cvt_f32_u32 v112, v112
  v_cvt_f32_u32 v113, v2
  v_lshlrev_b32 v114, 2, v3
  v_cvt_f32_u32 v114, v114
  s_mov_b32 s29, 0x80008000
  v_bfe_i32 v115, v2, 0, 1
  v_bfe_i32 v116, v2, 1, 1
  v_cmp_ne_u32 vcc, 0, v115
  v_and_b32 v115, s29, v115
  v_and_b32 v116, s29, v116
  v_xor_b32 v117, v115, v116
  v_mul_f32 v112, 0x3c800000, v112
  v_mul_f32 v96, v112, v114
  v_add_f32 v97, v96, v112
  v_add_f32 v98, v97, v112
  v_add_f32 v99, v98, v112
  v_cos_f32 v104, v96
  v_sin_f32 v108, v96
  v_cos_f32 v105, v97
  v_sin_f32 v109, v97
  v_cos_f32 v106, v98
  v_sin_f32 v110, v98
  v_cos_f32 v107, v99
  v_sin_f32 v111, v99
  v_cvt_pk_bf16_f32 v8, v104, v108
  v_cvt_pk_bf16_f32 v12, -v108, v104
  v_cvt_pk_bf16_f32 v9, v105, v109
  v_cvt_pk_bf16_f32 v13, -v109, v105
  v_cvt_pk_bf16_f32 v10, v106, v110
  v_cvt_pk_bf16_f32 v14, -v110, v106
  v_cvt_pk_bf16_f32 v11, v107, v111
  v_cvt_pk_bf16_f32 v15, -v111, v107
  v_cndmask_b32 v16, v8, v12, vcc
  v_cndmask_b32 v20, v12, v8, vcc
  v_xor_b32 v24, v115, v8
  v_xor_b32 v28, v115, v12
  v_xor_b32 v32, v117, v16
  v_xor_b32 v36, v116, v20
  v_xor_b32 v16, v116, v16
  v_xor_b32 v20, v117, v20
  v_cndmask_b32 v17, v9, v13, vcc
  v_cndmask_b32 v21, v13, v9, vcc
  v_xor_b32 v25, v115, v9
  v_xor_b32 v29, v115, v13
  v_xor_b32 v33, v117, v17
  v_xor_b32 v37, v116, v21
  v_xor_b32 v17, v116, v17
  v_xor_b32 v21, v117, v21
  v_cndmask_b32 v18, v10, v14, vcc
  v_cndmask_b32 v22, v14, v10, vcc
  v_xor_b32 v26, v115, v10
  v_xor_b32 v30, v115, v14
  v_xor_b32 v34, v117, v18
  v_xor_b32 v38, v116, v22
  v_xor_b32 v18, v116, v18
  v_xor_b32 v22, v117, v22
  v_cndmask_b32 v19, v11, v15, vcc
  v_cndmask_b32 v23, v15, v11, vcc
  v_xor_b32 v27, v115, v11
  v_xor_b32 v31, v115, v15
  v_xor_b32 v35, v117, v19
  v_xor_b32 v39, v116, v23
  v_xor_b32 v19, v116, v19
  v_xor_b32 v23, v117, v23
  v_mul_f32 v112, 0x3d000000, v112
  v_mul_f32 v96, v112, v114
  v_add_f32 v97, v96, v112
  v_add_f32 v98, v97, v112
  v_add_f32 v99, v98, v112
  v_mul_f32 v112, 16.0, v112
  v_add_f32 v100, v96, v112
  v_add_f32 v101, v97, v112
  v_add_f32 v102, v98, v112
  v_add_f32 v103, v99, v112
  v_cos_f32 v40, v96
  v_sin_f32 v44, v96
  v_cos_f32 v41, v97
  v_sin_f32 v45, v97
  v_cos_f32 v42, v98
  v_sin_f32 v46, v98
  v_cos_f32 v43, v99
  v_sin_f32 v47, v99
  v_cos_f32 v48, v100
  v_sin_f32 v52, v100
  v_cos_f32 v49, v101
  v_sin_f32 v53, v101
  v_cos_f32 v50, v102
  v_sin_f32 v54, v102
  v_cos_f32 v51, v103
  v_sin_f32 v55, v103
  v_mul_f32 v113, 0x3d000000, v113
  v_mul_f32 v96, v113, v114
  v_add_f32 v97, v96, v113
  v_add_f32 v98, v97, v113
  v_add_f32 v99, v98, v113
  v_cos_f32 v104, v96
  v_sin_f32 v108, v96
  v_cos_f32 v105, v97
  v_sin_f32 v109, v97
  v_cos_f32 v106, v98
  v_sin_f32 v110, v98
  v_cos_f32 v107, v99
  v_sin_f32 v111, v99
  v_cvt_pk_bf16_f32 v56, v104, v108
  v_cvt_pk_bf16_f32 v60, -v108, v104
  v_cvt_pk_bf16_f32 v57, v105, v109
  v_cvt_pk_bf16_f32 v61, -v109, v105
  v_cvt_pk_bf16_f32 v58, v106, v110
  v_cvt_pk_bf16_f32 v62, -v110, v106
  v_cvt_pk_bf16_f32 v59, v107, v111
  v_cvt_pk_bf16_f32 v63, -v111, v107
  v_xor_b32 v64, v115, v56
  v_xor_b32 v65, v115, v57
  v_xor_b32 v66, v115, v58
  v_xor_b32 v67, v115, v59
  v_xor_b32 v68, v115, v60
  v_xor_b32 v69, v115, v61
  v_xor_b32 v70, v115, v62
  v_xor_b32 v71, v115, v63
  v_mov_b32 v72, v56
  v_xor_b32 v73, s29, v57
  v_mov_b32 v74, v58
  v_xor_b32 v75, s29, v59
  v_mov_b32 v76, v60
  v_xor_b32 v77, s29, v61
  v_mov_b32 v78, v62
  v_xor_b32 v79, s29, v63
  v_mov_b32 v80, v64
  v_xor_b32 v81, s29, v65
  v_mov_b32 v82, v66
  v_xor_b32 v83, s29, v67
  v_mov_b32 v84, v68
  v_xor_b32 v85, s29, v69
  v_mov_b32 v86, v70
  v_xor_b32 v87, s29, v71
  v_and_b32 v7, 1, v3
  v_mul_u32_u24 v6, 4352, v7
  v_lshrrev_b32 v7, 1, v3
  v_mul_u32_u24 v7, 1088, v7
  v_add_u32 v6, v6, v7
  v_lshrrev_b32 v1, 1, v2
  v_lshlrev_b32 v1, 8, v1
  v_lshl_add_u32 v1, v3, 5, v1
  v_and_b32 v7, 1, v2
  v_lshl_add_u32 v1, v7, 4, v1
  v_lshl_add_u32 v6, v2, 2, v6
  s_lshl_b32 s32, s21, 6
  s_add_u32 s32, s32, 8192
  v_add_u32 v6, s32, v6
  v_mul_u32_u24 v7, 272, v2
  v_lshl_add_u32 v7, v3, 4, v7
  s_lshl_b32 s33, s20, 13
  s_add_u32 s33, s33, s27
  s_add_u32 s4, s16, 0x510000
  s_addc_u32 s5, s17, 0
  s_mov_b32 s6, 0x282000
  s_mov_b32 s7, 0x00020000
  s_mov_b32 s34, 0xffff0000
  s_waitcnt vmcnt(2)
  s_barrier
  ds_read_b128 v[96:99], v4 offset:0
  ds_read_b128 v[100:103], v4 offset:1024
  ds_read_b128 v[104:107], v4 offset:2048
  ds_read_b128 v[108:111], v4 offset:3072
  ds_read_b128 v[112:115], v4 offset:4096
  ds_read_b128 v[116:119], v4 offset:5120
  ds_read_b128 v[120:123], v4 offset:6144
  ds_read_b128 v[124:127], v4 offset:7168
  s_waitcnt lgkmcnt(7)
  v_mfma_f32_16x16x32_bf16 v[128:131], v[96:99], v[8:11], 0
  v_mfma_f32_16x16x32_bf16 v[132:135], v[96:99], v[12:15], 0
  s_waitcnt lgkmcnt(6)
  v_mfma_f32_16x16x32_bf16 v[128:131], v[100:103], v[16:19], v[128:131]
  v_mfma_f32_16x16x32_bf16 v[132:135], v[100:103], v[20:23], v[132:135]
  s_waitcnt lgkmcnt(5)
  v_mfma_f32_16x16x32_bf16 v[128:131], v[104:107], v[24:27], v[128:131]
  v_mfma_f32_16x16x32_bf16 v[132:135], v[104:107], v[28:31], v[132:135]
  s_waitcnt lgkmcnt(4)
  v_mfma_f32_16x16x32_bf16 v[128:131], v[108:111], v[32:35], v[128:131]
  v_mfma_f32_16x16x32_bf16 v[132:135], v[108:111], v[36:39], v[132:135]
  s_waitcnt lgkmcnt(3)
  v_mfma_f32_16x16x32_bf16 v[136:139], v[112:115], v[8:11], 0
  v_mfma_f32_16x16x32_bf16 v[140:143], v[112:115], v[12:15], 0
  s_waitcnt lgkmcnt(2)
  v_mfma_f32_16x16x32_bf16 v[136:139], v[116:119], v[16:19], v[136:139]
  v_mfma_f32_16x16x32_bf16 v[140:143], v[116:119], v[20:23], v[140:143]
  s_waitcnt lgkmcnt(1)
  v_mfma_f32_16x16x32_bf16 v[136:139], v[120:123], v[24:27], v[136:139]
  v_mfma_f32_16x16x32_bf16 v[140:143], v[120:123], v[28:31], v[140:143]
  s_waitcnt lgkmcnt(0)
  v_mfma_f32_16x16x32_bf16 v[136:139], v[124:127], v[32:35], v[136:139]
  v_mfma_f32_16x16x32_bf16 v[140:143], v[124:127], v[36:39], v[140:143]
  s_waitcnt vmcnt(1)
  v_lshlrev_b32 v96, 16, v88
  v_and_b32 v104, s34, v88
  v_lshlrev_b32 v97, 16, v89
  v_and_b32 v105, s34, v89
  v_lshlrev_b32 v98, 16, v90
  v_and_b32 v106, s34, v90
  v_lshlrev_b32 v99, 16, v91
  v_and_b32 v107, s34, v91
  s_waitcnt vmcnt(0)
  v_lshlrev_b32 v100, 16, v92
  v_and_b32 v108, s34, v92
  v_lshlrev_b32 v101, 16, v93
  v_and_b32 v109, s34, v93
  v_lshlrev_b32 v102, 16, v94
  v_and_b32 v110, s34, v94
  v_lshlrev_b32 v103, 16, v95
  v_and_b32 v111, s34, v95
  v_pk_mul_f32 v[144:145], v[132:133], v[44:45]
  v_pk_mul_f32 v[148:149], v[128:129], v[44:45]
  v_pk_mul_f32 v[146:147], v[134:135], v[46:47]
  v_pk_mul_f32 v[150:151], v[130:131], v[46:47]
  v_pk_fma_f32 v[128:129], v[128:129], v[40:41], v[144:145]
  v_pk_fma_f32 v[132:133], v[132:133], v[40:41], v[148:149] neg_lo:[0,0,1] neg_hi:[0,0,1]
  v_pk_fma_f32 v[130:131], v[130:131], v[42:43], v[146:147]
  v_pk_fma_f32 v[134:135], v[134:135], v[42:43], v[150:151] neg_lo:[0,0,1] neg_hi:[0,0,1]
  v_cvt_pk_bf16_f32 v152, v128, v132
  v_cvt_pk_bf16_f32 v153, v129, v133
  v_cvt_pk_bf16_f32 v154, v130, v134
  v_cvt_pk_bf16_f32 v155, v131, v135
  v_pk_mul_f32 v[144:145], v[140:141], v[52:53]
  v_pk_mul_f32 v[148:149], v[136:137], v[52:53]
  v_pk_mul_f32 v[146:147], v[142:143], v[54:55]
  v_pk_mul_f32 v[150:151], v[138:139], v[54:55]
  v_pk_fma_f32 v[136:137], v[136:137], v[48:49], v[144:145]
  v_pk_fma_f32 v[140:141], v[140:141], v[48:49], v[148:149] neg_lo:[0,0,1] neg_hi:[0,0,1]
  v_pk_fma_f32 v[138:139], v[138:139], v[50:51], v[146:147]
  v_pk_fma_f32 v[142:143], v[142:143], v[50:51], v[150:151] neg_lo:[0,0,1] neg_hi:[0,0,1]
  v_cvt_pk_bf16_f32 v156, v136, v140
  v_cvt_pk_bf16_f32 v157, v137, v141
  v_cvt_pk_bf16_f32 v158, v138, v142
  v_cvt_pk_bf16_f32 v159, v139, v143
  v_mfma_f32_16x16x32_bf16 v[112:115], v[56:59], v[152:155], 0
  v_mfma_f32_16x16x32_bf16 v[116:119], v[60:63], v[152:155], 0
  v_mfma_f32_16x16x32_bf16 v[112:115], v[64:67], v[156:159], v[112:115]
  v_mfma_f32_16x16x32_bf16 v[116:119], v[68:71], v[156:159], v[116:119]
  v_mfma_f32_16x16x32_bf16 v[120:123], v[72:75], v[152:155], 0
  v_mfma_f32_16x16x32_bf16 v[124:127], v[76:79], v[152:155], 0
  v_mfma_f32_16x16x32_bf16 v[120:123], v[80:83], v[156:159], v[120:123]
  v_mfma_f32_16x16x32_bf16 v[124:127], v[84:87], v[156:159], v[124:127]
  s_nop 3
  v_pk_mul_f32 v[144:145], v[116:117], v[104:105]
  v_pk_mul_f32 v[148:149], v[116:117], v[96:97]
  v_pk_mul_f32 v[146:147], v[118:119], v[106:107]
  v_pk_mul_f32 v[150:151], v[118:119], v[98:99]
  v_pk_fma_f32 v[116:117], v[112:113], v[104:105], v[148:149] neg_lo:[0,1,1] neg_hi:[0,1,1]
  v_pk_fma_f32 v[112:113], v[112:113], v[96:97], v[144:145] neg_lo:[0,0,1] neg_hi:[0,0,1]
  v_pk_fma_f32 v[118:119], v[114:115], v[106:107], v[150:151] neg_lo:[0,1,1] neg_hi:[0,1,1]
  v_pk_fma_f32 v[114:115], v[114:115], v[98:99], v[146:147] neg_lo:[0,0,1] neg_hi:[0,0,1]
  v_cvt_pk_bf16_f32 v88, v112, v116
  v_cvt_pk_bf16_f32 v89, v113, v117
  v_cvt_pk_bf16_f32 v90, v114, v118
  v_cvt_pk_bf16_f32 v91, v115, v119
  v_pk_mul_f32 v[144:145], v[124:125], v[108:109]
  v_pk_mul_f32 v[148:149], v[124:125], v[100:101]
  v_pk_mul_f32 v[146:147], v[126:127], v[110:111]
  v_pk_mul_f32 v[150:151], v[126:127], v[102:103]
  v_pk_fma_f32 v[124:125], v[120:121], v[108:109], v[148:149] neg_lo:[0,1,1] neg_hi:[0,1,1]
  v_pk_fma_f32 v[120:121], v[120:121], v[100:101], v[144:145] neg_lo:[0,0,1] neg_hi:[0,0,1]
  v_pk_fma_f32 v[126:127], v[122:123], v[110:111], v[150:151] neg_lo:[0,1,1] neg_hi:[0,1,1]
  v_pk_fma_f32 v[122:123], v[122:123], v[102:103], v[146:147] neg_lo:[0,0,1] neg_hi:[0,0,1]
  v_cvt_pk_bf16_f32 v92, v120, v124
  v_cvt_pk_bf16_f32 v93, v121, v125
  v_cvt_pk_bf16_f32 v94, v122, v126
  v_cvt_pk_bf16_f32 v95, v123, v127
  v_mfma_f32_16x16x32_bf16 v[128:131], v[56:59], v[88:91], 0
  v_mfma_f32_16x16x32_bf16 v[132:135], v[60:63], v[88:91], 0
  v_mfma_f32_16x16x32_bf16 v[128:131], v[64:67], v[92:95], v[128:131]
  v_mfma_f32_16x16x32_bf16 v[132:135], v[68:71], v[92:95], v[132:135]
  v_mfma_f32_16x16x32_bf16 v[136:139], v[72:75], v[88:91], 0
  v_mfma_f32_16x16x32_bf16 v[140:143], v[76:79], v[88:91], 0
  v_mfma_f32_16x16x32_bf16 v[136:139], v[80:83], v[92:95], v[136:139]
  v_mfma_f32_16x16x32_bf16 v[140:143], v[84:87], v[92:95], v[140:143]
  s_nop 3
  v_pk_mul_f32 v[144:145], v[132:133], v[44:45]
  v_pk_mul_f32 v[148:149], v[128:129], v[44:45]
  v_pk_mul_f32 v[146:147], v[134:135], v[46:47]
  v_pk_mul_f32 v[150:151], v[130:131], v[46:47]
  v_pk_fma_f32 v[128:129], v[128:129], v[40:41], v[144:145]
  v_pk_fma_f32 v[132:133], v[132:133], v[40:41], v[148:149] neg_lo:[0,0,1] neg_hi:[0,0,1]
  v_pk_fma_f32 v[130:131], v[130:131], v[42:43], v[146:147]
  v_pk_fma_f32 v[134:135], v[134:135], v[42:43], v[150:151] neg_lo:[0,0,1] neg_hi:[0,0,1]
  v_cvt_pk_bf16_f32 v152, v128, v132
  ds_write_b32 v6, v152 offset:0
  v_cvt_pk_bf16_f32 v153, v129, v133
  ds_write_b32 v6, v153 offset:272
  v_cvt_pk_bf16_f32 v154, v130, v134
  ds_write_b32 v6, v154 offset:544
  v_cvt_pk_bf16_f32 v155, v131, v135
  ds_write_b32 v6, v155 offset:816
  v_pk_mul_f32 v[144:145], v[140:141], v[52:53]
  v_pk_mul_f32 v[148:149], v[136:137], v[52:53]
  v_pk_mul_f32 v[146:147], v[142:143], v[54:55]
  v_pk_mul_f32 v[150:151], v[138:139], v[54:55]
  v_pk_fma_f32 v[136:137], v[136:137], v[48:49], v[144:145]
  v_pk_fma_f32 v[140:141], v[140:141], v[48:49], v[148:149] neg_lo:[0,0,1] neg_hi:[0,0,1]
  v_pk_fma_f32 v[138:139], v[138:139], v[50:51], v[146:147]
  v_pk_fma_f32 v[142:143], v[142:143], v[50:51], v[150:151] neg_lo:[0,0,1] neg_hi:[0,0,1]
  v_cvt_pk_bf16_f32 v156, v136, v140
  ds_write_b32 v6, v156 offset:2176
  v_cvt_pk_bf16_f32 v157, v137, v141
  ds_write_b32 v6, v157 offset:2448
  v_cvt_pk_bf16_f32 v158, v138, v142
  ds_write_b32 v6, v158 offset:2720
  v_cvt_pk_bf16_f32 v159, v139, v143
  ds_write_b32 v6, v159 offset:2992
  s_waitcnt lgkmcnt(0)
  s_barrier
  ds_read_b128 v[56:59], v7 offset:8192
  ds_read_b128 v[60:63], v7 offset:8256
  ds_read_b128 v[64:67], v7 offset:8320
  ds_read_b128 v[68:71], v7 offset:8384
  ds_read_b128 v[72:75], v7 offset:12544
  ds_read_b128 v[76:79], v7 offset:12608
  ds_read_b128 v[80:83], v7 offset:12672
  ds_read_b128 v[84:87], v7 offset:12736
  s_waitcnt lgkmcnt(7)
  v_mfma_f32_16x16x32_bf16 v[112:115], v[56:59], v[8:11], 0
  v_mfma_f32_16x16x32_bf16 v[116:119], v[56:59], v[12:15], 0
  s_waitcnt lgkmcnt(6)
  v_mfma_f32_16x16x32_bf16 v[112:115], v[60:63], v[16:19], v[112:115]
  v_mfma_f32_16x16x32_bf16 v[116:119], v[60:63], v[20:23], v[116:119]
  s_waitcnt lgkmcnt(5)
  v_mfma_f32_16x16x32_bf16 v[112:115], v[64:67], v[24:27], v[112:115]
  v_mfma_f32_16x16x32_bf16 v[116:119], v[64:67], v[28:31], v[116:119]
  s_waitcnt lgkmcnt(4)
  v_mfma_f32_16x16x32_bf16 v[112:115], v[68:71], v[32:35], v[112:115]
  v_mfma_f32_16x16x32_bf16 v[116:119], v[68:71], v[36:39], v[116:119]
  s_waitcnt lgkmcnt(3)
  v_mfma_f32_16x16x32_bf16 v[120:123], v[72:75], v[8:11], 0
  v_mfma_f32_16x16x32_bf16 v[124:127], v[72:75], v[12:15], 0
  s_waitcnt lgkmcnt(2)
  v_mfma_f32_16x16x32_bf16 v[120:123], v[76:79], v[16:19], v[120:123]
  v_mfma_f32_16x16x32_bf16 v[124:127], v[76:79], v[20:23], v[124:127]
  s_waitcnt lgkmcnt(1)
  v_mfma_f32_16x16x32_bf16 v[120:123], v[80:83], v[24:27], v[120:123]
  v_mfma_f32_16x16x32_bf16 v[124:127], v[80:83], v[28:31], v[124:127]
  s_waitcnt lgkmcnt(0)
  v_mfma_f32_16x16x32_bf16 v[120:123], v[84:87], v[32:35], v[120:123]
  v_mfma_f32_16x16x32_bf16 v[124:127], v[84:87], v[36:39], v[124:127]
  v_cvt_pk_bf16_f32 v88, v112, v116
  v_cvt_pk_bf16_f32 v89, v113, v117
  v_cvt_pk_bf16_f32 v90, v114, v118
  v_cvt_pk_bf16_f32 v91, v115, v119
  s_nop 3
  v_cvt_pk_bf16_f32 v92, v120, v124
  v_cvt_pk_bf16_f32 v93, v121, v125
  v_cvt_pk_bf16_f32 v94, v122, v126
  v_cvt_pk_bf16_f32 v95, v123, v127
  s_mov_b32 vcc_lo, 0x55555555
  s_mov_b32 vcc_hi, 0x55555555
  s_nop 1
  v_cndmask_b32_dpp v112, v92, v88, vcc quad_perm:[1,0,3,2] row_mask:0xf bank_mask:0xf
  v_cndmask_b32_dpp v113, v93, v89, vcc quad_perm:[1,0,3,2] row_mask:0xf bank_mask:0xf
  v_cndmask_b32_dpp v114, v94, v90, vcc quad_perm:[1,0,3,2] row_mask:0xf bank_mask:0xf
  v_cndmask_b32_dpp v115, v95, v91, vcc quad_perm:[1,0,3,2] row_mask:0xf bank_mask:0xf
  buffer_store_dwordx4 v[112:115], v1, s[4:7], s33 offen offset:0
  s_mov_b32 vcc_lo, 0xaaaaaaaa
  s_mov_b32 vcc_hi, 0xaaaaaaaa
  s_nop 1
  v_cndmask_b32_dpp v120, v88, v92, vcc quad_perm:[1,0,3,2] row_mask:0xf bank_mask:0xf
  v_cndmask_b32_dpp v121, v89, v93, vcc quad_perm:[1,0,3,2] row_mask:0xf bank_mask:0xf
  v_cndmask_b32_dpp v122, v90, v94, vcc quad_perm:[1,0,3,2] row_mask:0xf bank_mask:0xf
  v_cndmask_b32_dpp v123, v91, v95, vcc quad_perm:[1,0,3,2] row_mask:0xf bank_mask:0xf
  buffer_store_dwordx4 v[120:123], v1, s[4:7], s33 offen offset:128
  s_endpgm
.Lk2_kernel_other5:
  s_cmp_ge_u32 s2, 461
  s_cbranch_scc1 .Lk2_kernel_other6
  s_load_dwordx2 s[4:5], s[0:1], 56
  s_load_dwordx2 s[16:17], s[0:1], 80
  s_sub_u32 s3, s2, 321
  v_lshrrev_b32 v1, 6, v0
  v_and_b32 v3, 63, v0
  v_readfirstlane_b32 s20, v1
  v_lshrrev_b32 v4, 2, v3
  v_mul_u32_u24 v4, 1280, v4
  v_and_b32 v1, 3, v0
  v_lshl_add_u32 v4, v1, 4, v4
  s_mov_b32 s19, s20
  s_mul_i32 s22, s3, 3277
  s_lshr_b32 s22, s22, 16
  s_mul_i32 s21, s22, 20
  s_sub_u32 s3, s3, s21
  s_lshl_b32 s22, s22, 2
  s_add_u32 s19, s19, s22
  s_mul_i32 s21, s19, 2
  s_mul_i32 s24, s21, 40960
  s_lshl_b32 s25, s3, 6
  s_add_u32 s24, s24, s25
  s_mov_b32 s6, 0x21c000
  s_mov_b32 s7, 0x00020000
  s_waitcnt lgkmcnt(0)
  buffer_load_dwordx4 v[8:11], v4, s[4:7], s24 offen
  s_add_u32 s24, s24, 20480
  buffer_load_dwordx4 v[12:15], v4, s[4:7], s24 offen
  s_add_u32 s24, s24, 20480
  buffer_load_dwordx4 v[16:19], v4, s[4:7], s24 offen
  s_add_u32 s24, s24, 20480
  buffer_load_dwordx4 v[20:23], v4, s[4:7], s24 offen
  s_mul_i32 s22, s3, 13108
  s_lshr_b32 s22, s22, 16
  s_mul_i32 s23, s22, 5
  s_sub_u32 s23, s3, s23
  s_mul_i32 s26, s22, 560
  s_lshl_b32 s30, s23, 1
  s_add_u32 s26, s26, s30
  s_cmp_gt_u32 s23, 2
  s_cselect_b32 s30, 274, 0
  s_add_u32 s26, s26, s30
  s_cmp_eq_u32 s23, 2
  s_cselect_b32 s30, 280, 1
  s_add_u32 s27, s26, s30
  s_mul_i32 s30, s21, 5
  s_add_u32 s26, s26, s30
  s_add_u32 s27, s27, s30
  s_lshl_b32 s26, s26, 10
  s_lshl_b32 s27, s27, 10
  s_add_u32 s12, s16, 0x19d8000
  s_addc_u32 s13, s17, 0
  s_mov_b32 s14, 0x230000
  s_mov_b32 s15, 0x00020000
  s_cmp_eq_u32 s23, 2
  s_mov_b32 s32, 0x05040100
  s_mov_b32 s33, 0x07060302
  s_cselect_b32 s34, 3, 4
  s_cselect_b32 s35, 32, 8
  v_lshlrev_b32 v3, 4, v3
  s_lshl_b32 s36, s20, 12
  v_add_u32 v5, s36, v3
  v_bfe_u32 v2, v0, 4, 2
  v_bfe_u32 v6, v0, 2, 2
  v_lshl_add_u32 v6, v2, 3, v6
  v_lshlrev_b32 v6, 6, v6
  v_lshlrev_b32 v1, s34, v1
  v_add3_u32 v6, v6, v1, s36
  v_add_u32 v4, s35, v6
  s_cmp_eq_u32 s23, 2
  s_cbranch_scc1 .Lk2_kernel_hal8
  s_waitcnt vmcnt(3)
  v_perm_b32 v40, v9, v8, s32
  v_perm_b32 v41, v11, v10, s32
  v_perm_b32 v42, v9, v8, s33
  v_perm_b32 v43, v11, v10, s33
  s_waitcnt vmcnt(2)
  v_perm_b32 v44, v13, v12, s32
  v_perm_b32 v45, v15, v14, s32
  v_perm_b32 v46, v13, v12, s33
  v_perm_b32 v47, v15, v14, s33
  ds_write_b128 v5, v[40:43] offset:0
  ds_write_b128 v5, v[44:47] offset:1024
  ds_read_b64_tr_b16 v[24:25], v6 offset:0
  ds_read_b64_tr_b16 v[26:27], v6 offset:256
  ds_read_b64_tr_b16 v[28:29], v4 offset:0
  ds_read_b64_tr_b16 v[30:31], v4 offset:256
  s_waitcnt vmcnt(1)
  v_perm_b32 v40, v17, v16, s32
  v_perm_b32 v41, v19, v18, s32
  v_perm_b32 v42, v17, v16, s33
  v_perm_b32 v43, v19, v18, s33
  s_waitcnt vmcnt(0)
  v_perm_b32 v44, v21, v20, s32
  v_perm_b32 v45, v23, v22, s32
  v_perm_b32 v46, v21, v20, s33
  v_perm_b32 v47, v23, v22, s33
  ds_write_b128 v5, v[40:43] offset:2048
  ds_write_b128 v5, v[44:47] offset:3072
  ds_read_b64_tr_b16 v[32:33], v6 offset:2048
  ds_read_b64_tr_b16 v[34:35], v6 offset:2304
  ds_read_b64_tr_b16 v[36:37], v4 offset:2048
  ds_read_b64_tr_b16 v[38:39], v4 offset:2304
  s_waitcnt lgkmcnt(8)
  buffer_store_dwordx4 v[24:27], v3, s[12:15], s26 offen
  s_add_u32 s26, s26, 5120
  s_waitcnt lgkmcnt(6)
  buffer_store_dwordx4 v[28:31], v3, s[12:15], s27 offen
  s_add_u32 s27, s27, 5120
  s_waitcnt lgkmcnt(2)
  buffer_store_dwordx4 v[32:35], v3, s[12:15], s26 offen
  s_waitcnt lgkmcnt(0)
  buffer_store_dwordx4 v[36:39], v3, s[12:15], s27 offen
  s_endpgm
.Lk2_kernel_hal8:
  s_waitcnt vmcnt(3)
  ds_write_b128 v5, v[8:11] offset:0
  s_waitcnt vmcnt(2)
  ds_write_b128 v5, v[12:15] offset:1024
  ds_read_b64_tr_b16 v[24:25], v6 offset:0
  ds_read_b64_tr_b16 v[26:27], v6 offset:256
  ds_read_b64_tr_b16 v[28:29], v4 offset:0
  ds_read_b64_tr_b16 v[30:31], v4 offset:256
  s_waitcnt vmcnt(1)
  ds_write_b128 v5, v[16:19] offset:2048
  s_waitcnt vmcnt(0)
  ds_write_b128 v5, v[20:23] offset:3072
  ds_read_b64_tr_b16 v[32:33], v6 offset:2048
  ds_read_b64_tr_b16 v[34:35], v6 offset:2304
  ds_read_b64_tr_b16 v[36:37], v4 offset:2048
  ds_read_b64_tr_b16 v[38:39], v4 offset:2304
  s_waitcnt lgkmcnt(8)
  buffer_store_dwordx4 v[24:27], v3, s[12:15], s26 offen
  s_add_u32 s26, s26, 5120
  s_waitcnt lgkmcnt(6)
  buffer_store_dwordx4 v[28:31], v3, s[12:15], s27 offen
  s_add_u32 s27, s27, 5120
  s_waitcnt lgkmcnt(2)
  buffer_store_dwordx4 v[32:35], v3, s[12:15], s26 offen
  s_waitcnt lgkmcnt(0)
  buffer_store_dwordx4 v[36:39], v3, s[12:15], s27 offen
.Lk2_kernel_pdone7:
  s_endpgm
.Lk2_kernel_other6:
  s_cmp_ge_u32 s2, 501
  s_cbranch_scc1 .Lk2_kernel_other10
  s_load_dwordx2 s[16:17], s[0:1], 80
  s_sub_u32 s3, s2, 461
  v_lshrrev_b32 v1, 6, v0
  v_and_b32 v2, 63, v0
  v_readfirstlane_b32 s20, v1
  v_lshlrev_b32 v2, 4, v2
  s_mul_i32 s21, s3, 6554
  s_lshr_b32 s21, s21, 16
  s_mul_i32 s21, s21, 190
  s_add_u32 s21, s21, s3
  s_mul_i32 s22, s20, 50
  s_add_u32 s21, s21, s22
  s_lshl_b32 s21, s21, 10
  s_waitcnt lgkmcnt(0)
  s_add_u32 s4, s16, 0x1618000
  s_addc_u32 s5, s17, 0
  s_mov_b32 s6, 0xc8000
  s_mov_b32 s7, 0x00020000
  buffer_load_dwordx4 v[8:11], v2, s[4:7], s21 offen
  s_add_u32 s21, s21, 10240
  buffer_load_dwordx4 v[12:15], v2, s[4:7], s21 offen
  s_add_u32 s21, s21, 10240
  buffer_load_dwordx4 v[16:19], v2, s[4:7], s21 offen
  s_add_u32 s21, s21, 10240
  buffer_load_dwordx4 v[20:23], v2, s[4:7], s21 offen
  s_add_u32 s21, s21, 10240
  buffer_load_dwordx4 v[24:27], v2, s[4:7], s21 offen
  v_mov_b32 v4, 0x3f803f80
  v_mov_b32 v5, 0x3f803f80
  v_mov_b32 v6, 0x3f803f80
  v_mov_b32 v7, 0x3f803f80
  v_lshlrev_b32 v1, 4, v0
  s_add_u32 s12, s16, 0x1c0b000
  s_addc_u32 s13, s17, 0
  s_mov_b32 s14, 0x3000
  s_mov_b32 s15, 0x00020000
  s_lshl_b32 s28, s3, 12
  v_mov_b32 v32, 0
  v_mov_b32 v33, 0
  v_mov_b32 v34, 0
  v_mov_b32 v35, 0
  buffer_store_dwordx4 v[32:35], v1, s[12:15], s28 offen
  s_add_u32 s12, s16, 0x1c0a000
  s_addc_u32 s13, s17, 0
  s_mov_b32 s14, 0xa00
  s_mov_b32 s15, 0x00020000
  s_waitcnt vmcnt(5)
  v_mfma_f32_16x16x32_bf16 v[28:31], v[8:11], v[4:7], 0
  s_waitcnt vmcnt(4)
  v_mfma_f32_16x16x32_bf16 v[28:31], v[12:15], v[4:7], v[28:31]
  s_waitcnt vmcnt(3)
  v_mfma_f32_16x16x32_bf16 v[28:31], v[16:19], v[4:7], v[28:31]
  s_waitcnt vmcnt(2)
  v_mfma_f32_16x16x32_bf16 v[28:31], v[20:23], v[4:7], v[28:31]
  s_waitcnt vmcnt(1)
  v_mfma_f32_16x16x32_bf16 v[28:31], v[24:27], v[4:7], v[28:31]
  s_nop 7
  ds_write_b128 v1, v[28:31]
  s_waitcnt lgkmcnt(0)
  s_barrier
  s_cmp_gt_u32 s20, 0
  s_cbranch_scc1 .Lk2_kernel_pe11
  ds_read_b128 v[8:11], v2 offset:0
  ds_read_b128 v[12:15], v2 offset:1024
  ds_read_b128 v[16:19], v2 offset:2048
  ds_read_b128 v[20:23], v2 offset:3072
  s_lshl_b32 s28, s3, 6
  v_and_b32 v3, 15, v0
  v_mov_b32 v1, 0x40000000
  v_cmp_eq_u32 vcc, 0, v3
  s_nop 1
  v_cndmask_b32 v1, v1, v0, vcc
  s_waitcnt lgkmcnt(2)
  v_add_f32 v8, v8, v12
  s_waitcnt lgkmcnt(0)
  v_add_f32 v16, v16, v20
  v_add_f32 v8, v8, v16
  v_add_f32 v9, v9, v13
  v_add_f32 v17, v17, v21
  v_add_f32 v9, v9, v17
  v_add_f32 v10, v10, v14
  v_add_f32 v18, v18, v22
  v_add_f32 v10, v10, v18
  v_add_f32 v11, v11, v15
  v_add_f32 v19, v19, v23
  v_add_f32 v11, v11, v19
  buffer_store_dwordx4 v[8:11], v1, s[12:15], s28 offen
.Lk2_kernel_pe11:
  s_endpgm
.Lk2_kernel_other10:
  s_cmp_ge_u32 s2, 613
  s_cbranch_scc1 .Lk2_kernel_other12
  s_load_dwordx2 s[16:17], s[0:1], 80
  s_sub_u32 s3, s2, 501
  v_lshrrev_b32 v1, 6, v0
  v_and_b32 v2, 63, v0
  v_readfirstlane_b32 s20, v1
  v_lshlrev_b32 v2, 4, v2
  s_mul_i32 s21, s3, 9363
  s_lshr_b32 s21, s21, 16
  s_mul_i32 s21, s21, 133
  s_add_u32 s21, s21, s3
  s_mul_i32 s22, s20, 35
  s_add_u32 s21, s21, s22
  s_lshl_b32 s21, s21, 10
  s_waitcnt lgkmcnt(0)
  s_add_u32 s4, s16, 0x17a8000
  s_addc_u32 s5, s17, 0
  s_mov_b32 s6, 0x230000
  s_mov_b32 s7, 0x00020000
  buffer_load_dwordx4 v[8:11], v2, s[4:7], s21 offen
  s_add_u32 s21, s21, 7168
  buffer_load_dwordx4 v[12:15], v2, s[4:7], s21 offen
  s_add_u32 s21, s21, 7168
  buffer_load_dwordx4 v[16:19], v2, s[4:7], s21 offen
  s_add_u32 s21, s21, 7168
  buffer_load_dwordx4 v[20:23], v2, s[4:7], s21 offen
  s_add_u32 s21, s21, 7168
  buffer_load_dwordx4 v[24:27], v2, s[4:7], s21 offen
  v_mov_b32 v4, 0x3f803f80
  v_mov_b32 v5, 0x3f803f80
  v_mov_b32 v6, 0x3f803f80
  v_mov_b32 v7, 0x3f803f80
  v_lshlrev_b32 v1, 4, v0
  s_add_u32 s12, s16, 0x1c08000
  s_addc_u32 s13, s17, 0
  s_mov_b32 s14, 0x1c00
  s_mov_b32 s15, 0x00020000
  s_waitcnt vmcnt(4)
  v_mfma_f32_16x16x32_bf16 v[28:31], v[8:11], v[4:7], 0
  s_waitcnt vmcnt(3)
  v_mfma_f32_16x16x32_bf16 v[28:31], v[12:15], v[4:7], v[28:31]
  s_waitcnt vmcnt(2)
  v_mfma_f32_16x16x32_bf16 v[28:31], v[16:19], v[4:7], v[28:31]
  s_waitcnt vmcnt(1)
  v_mfma_f32_16x16x32_bf16 v[28:31], v[20:23], v[4:7], v[28:31]
  s_waitcnt vmcnt(0)
  v_mfma_f32_16x16x32_bf16 v[28:31], v[24:27], v[4:7], v[28:31]
  s_nop 7
  ds_write_b128 v1, v[28:31]
  s_waitcnt lgkmcnt(0)
  s_barrier
  s_cmp_gt_u32 s20, 0
  s_cbranch_scc1 .Lk2_kernel_pe13
  ds_read_b128 v[8:11], v2 offset:0
  ds_read_b128 v[12:15], v2 offset:1024
  ds_read_b128 v[16:19], v2 offset:2048
  ds_read_b128 v[20:23], v2 offset:3072
  s_lshl_b32 s28, s3, 6
  v_and_b32 v3, 15, v0
  v_mov_b32 v1, 0x40000000
  v_cmp_eq_u32 vcc, 0, v3
  s_nop 1
  v_cndmask_b32 v1, v1, v0, vcc
  s_waitcnt lgkmcnt(2)
  v_add_f32 v8, v8, v12
  s_waitcnt lgkmcnt(0)
  v_add_f32 v16, v16, v20
  v_add_f32 v8, v8, v16
  v_add_f32 v9, v9, v13
  v_add_f32 v17, v17, v21
  v_add_f32 v9, v9, v17
  v_add_f32 v10, v10, v14
  v_add_f32 v18, v18, v22
  v_add_f32 v10, v10, v18
  v_add_f32 v11, v11, v15
  v_add_f32 v19, v19, v23
  v_add_f32 v11, v11, v19
  buffer_store_dwordx4 v[8:11], v1, s[12:15], s28 offen
.Lk2_kernel_pe13:
  s_endpgm
.Lk2_kernel_other12:
  s_endpgm

.globl kf_kernel
.p2align 8
.type kf_kernel,@function
kf_kernel:
  s_cmp_ge_u32 s2, 256
  s_cbranch_scc1 .Lkf_kernel_other2
  s_load_dwordx2 s[16:17], s[0:1], 80
  s_load_dwordx2 s[12:13], s[0:1], 0
  v_lshrrev_b32 v1, 6, v0
  v_and_b32 v3, 63, v0
  v_readfirstlane_b32 s20, v1
  v_lshrrev_b32 v2, 4, v3
  v_and_b32 v1, 15, v0
  v_bfe_u32 v5, v0, 4, 3
  v_xor_b32 v5, v5, v0
  v_and_b32 v5, 7, v5
  v_lshrrev_b32 v4, 3, v3
  v_lshlrev_b32 v4, 13, v4
  v_lshl_add_u32 v4, v5, 4, v4
  v_lshlrev_b32 v3, 4, v3
  s_lshr_b32 s21, s2, 5
  s_and_b32 s22, s2, 7
  s_lshl_b32 s21, s21, 3
  s_add_u32 s21, s21, s22
  s_bfe_u32 s22, s2, 0x20003
  s_lshl_b32 s23, s21, 7
  s_lshl_b32 s24, s20, 16
  s_add_u32 s23, s23, s24
  s_lshl_b32 s24, s20, 10
  s_lshl_b32 s26, s21, 3
  s_add_u32 s26, s26, s20
  s_mul_i32 s27, s26, 5120
  s_mul_i32 s25, s20, 5120
  s_add_u32 s25, s25, 49152
  s_and_b32 s29, s20, 3
  s_lshr_b32 s30, s20, 2
  s_lshr_b32 s19, s29, 1
  s_and_b32 s18, s20, 1
  s_lshl_b32 s54, s30, 1
  s_add_u32 s54, s54, s19
  s_xor_b32 s55, s30, s18
  s_mul_i32 s33, s22, 200
  s_mul_i32 s31, s54, 50
  s_add_u32 s31, s31, s33
  s_add_u32 s32, s31, s18
  s_add_u32 s32, s32, 8
  s_lshl_b32 s32, s32, 10
  s_lshl_b32 s33, s29, 1
  s_add_u32 s31, s31, s33
  s_lshl_b32 s31, s31, 10
  s_mul_i32 s33, s19, 102400
  s_sub_u32 s33, 10240, s33
  v_lshlrev_b32 v88, 1, v1
  v_cvt_f32_u32 v88, v88
  v_lshlrev_b32 v90, 2, v2
  v_cvt_f32_u32 v90, v90
  v_add_f32 v89, 1.0, v88
  v_mul_f32 v91, 0x3d000000, v88
  v_mul_f32 v92, 0x3d000000, v89
  v_mul_f32 v64, v91, v90
  v_mul_f32 v68, v92, v90
  v_add_f32 v65, v64, v91
  v_add_f32 v69, v68, v92
  v_add_f32 v66, v65, v91
  v_add_f32 v70, v69, v92
  v_add_f32 v67, v66, v91
  v_add_f32 v71, v70, v92
  v_cos_f32 v72, v64
  v_sin_f32 v80, v64
  v_cos_f32 v73, v65
  v_sin_f32 v81, v65
  v_cos_f32 v74, v66
  v_sin_f32 v82, v66
  v_cos_f32 v75, v67
  v_sin_f32 v83, v67
  v_cos_f32 v76, v68
  v_sin_f32 v84, v68
  v_cos_f32 v77, v69
  v_sin_f32 v85, v69
  v_cos_f32 v78, v70
  v_sin_f32 v86, v70
  v_cos_f32 v79, v71
  v_sin_f32 v87, v71
  v_mul_f32 v64, 0x3d4ccccd, v64
  v_mul_f32 v65, 0x3d4ccccd, v65
  v_mul_f32 v66, 0x3d4ccccd, v66
  v_mul_f32 v67, 0x3d4ccccd, v67
  v_mul_f32 v68, 0x3d4ccccd, v68
  v_mul_f32 v69, 0x3d4ccccd, v69
  v_mul_f32 v70, 0x3d4ccccd, v70
  v_mul_f32 v71, 0x3d4ccccd, v71
  v_cos_f32 v40, v64
  v_cvt_pk_bf16_f32 v8, v72, v80
  v_cvt_pk_bf16_f32 v12, -v80, v72
  v_sin_f32 v44, v64
  v_cvt_pk_bf16_f32 v27, v72, -v80
  v_cvt_pk_bf16_f32 v31, -v80, -v72
  v_cos_f32 v41, v65
  v_cvt_pk_bf16_f32 v9, v73, v81
  v_cvt_pk_bf16_f32 v13, -v81, v73
  v_sin_f32 v45, v65
  v_cvt_pk_bf16_f32 v26, v73, -v81
  s_waitcnt lgkmcnt(0)
  s_add_u32 s4, s16, 0x510000
  s_addc_u32 s5, s17, 0
  s_mov_b32 s6, 0x282000
  s_mov_b32 s7, 0x00020000
  s_add_u32 m0, s24, 0
  s_nop 0
  buffer_load_dwordx4 v4, s[4:7], s23 offen lds
  s_add_u32 s23, s23, 524288
  s_add_u32 m0, s24, 8192
  s_nop 0
  buffer_load_dwordx4 v4, s[4:7], s23 offen lds
  s_add_u32 s23, s23, 524288
  s_add_u32 m0, s24, 16384
  s_nop 0
  buffer_load_dwordx4 v4, s[4:7], s23 offen lds
  s_add_u32 s23, s23, 524288
  s_add_u32 m0, s24, 24576
  s_nop 0
  buffer_load_dwordx4 v4, s[4:7], s23 offen lds
  s_add_u32 s23, s23, 524288
  s_add_u32 m0, s24, 32768
  s_nop 0
  buffer_load_dwordx4 v4, s[4:7], s23 offen lds
  s_add_u32 s23, s23, 524288
  s_add_u32 m0, s24, 40960
  s_nop 0
  buffer_load_dwordx4 v4, s[4:7], s23 offen lds
  v_cvt_pk_bf16_f32 v30, -v81, -v73
  v_cos_f32 v42, v66
  v_cvt_pk_bf16_f32 v10, v74, v82
  v_cvt_pk_bf16_f32 v14, -v82, v74
  v_sin_f32 v46, v66
  v_cvt_pk_bf16_f32 v25, v74, -v82
  v_cvt_pk_bf16_f32 v29, -v82, -v74
  v_cos_f32 v43, v67
  v_cvt_pk_bf16_f32 v11, v75, v83
  v_cvt_pk_bf16_f32 v15, -v83, v75
  v_sin_f32 v47, v67
  v_cvt_pk_bf16_f32 v24, v75, -v83
  v_cvt_pk_bf16_f32 v28, -v83, -v75
  v_cos_f32 v48, v68
  v_cvt_pk_bf16_f32 v16, v76, v84
  v_cvt_pk_bf16_f32 v20, -v84, v76
  v_sin_f32 v52, v68
  v_cvt_pk_bf16_f32 v35, -v76, v84
  v_cvt_pk_bf16_f32 v39, v84, v76
  v_cos_f32 v49, v69
  v_cvt_pk_bf16_f32 v17, v77, v85
  v_cvt_pk_bf16_f32 v21, -v85, v77
  v_sin_f32 v53, v69
  v_cvt_pk_bf16_f32 v34, -v77, v85
  v_cvt_pk_bf16_f32 v38, v85, v77
  v_cos_f32 v50, v70
  v_cvt_pk_bf16_f32 v18, v78, v86
  v_cvt_pk_bf16_f32 v22, -v86, v78
  v_sin_f32 v54, v70
  v_cvt_pk_bf16_f32 v33, -v78, v86
  v_cvt_pk_bf16_f32 v37, v86, v78
  v_cos_f32 v51, v71
  v_cvt_pk_bf16_f32 v19, v79, v87
  v_cvt_pk_bf16_f32 v23, -v87, v79
  v_sin_f32 v55, v71
  v_cvt_pk_bf16_f32 v32, -v79, v87
  v_cvt_pk_bf16_f32 v36, v87, v79
  v_lshrrev_b32 v5, 2, v1
  v_add_u32 v88, v5, v1
  v_mad_u32_u24 v89, v5, 5, 4
  v_cvt_f32_u32 v88, v88
  v_cvt_f32_u32 v89, v89
  v_mul_f32 v91, 0x3d4ccccd, v88
  v_mul_f32 v92, 0x3d4ccccd, v89
  v_mul_f32 v64, v91, v90
  v_mul_f32 v68, v92, v90
  v_add_f32 v65, v64, v91
  v_add_f32 v69, v68, v92
  v_add_f32 v66, v65, v91
  v_add_f32 v70, v69, v92
  v_add_f32 v67, v66, v91
  v_add_f32 v71, v70, v92
  v_cos_f32 v72, v64
  v_sin_f32 v80, v64
  v_cos_f32 v73, v65
  v_sin_f32 v81, v65
  v_cos_f32 v74, v66
  v_sin_f32 v82, v66
  v_cos_f32 v75, v67
  v_sin_f32 v83, v67
  v_cos_f32 v76, v68
  v_sin_f32 v84, v68
  v_cos_f32 v77, v69
  v_sin_f32 v85, v69
  v_cos_f32 v78, v70
  v_sin_f32 v86, v70
  v_cos_f32 v79, v71
  v_sin_f32 v87, v71
  v_cmp_gt_u32 vcc, 3, v2
  v_cmp_gt_u32 s[34:35], 2, v2
  v_cvt_pk_bf16_f32 v56, v72, v80
  v_cvt_pk_bf16_f32 v57, v73, v81
  v_cvt_pk_bf16_f32 v58, v74, v82
  v_cvt_pk_bf16_f32 v59, v75, v83
  v_cvt_pk_bf16_f32 v60, v76, v84
  v_cvt_pk_bf16_f32 v61, v77, v85
  v_cvt_pk_bf16_f32 v62, v78, v86
  v_cvt_pk_bf16_f32 v63, v79, v87
  v_cndmask_b32 v56, 0, v56, vcc
  v_cndmask_b32 v57, 0, v57, vcc
  s_mov_b32 s14, 0x280000
  s_mov_b32 s15, 0x00020000
  s_mov_b32 m0, s25
  s_nop 0
  buffer_load_dwordx4 v3, s[12:15], s27 offen offset:0 lds
  buffer_load_dwordx4 v3, s[12:15], s27 offen offset:1024 lds
  buffer_load_dwordx4 v3, s[12:15], s27 offen offset:2048 lds
  buffer_load_dwordx4 v3, s[12:15], s27 offen offset:3072 lds
  s_add_u32 m0, s25, 4096
  s_add_u32 s27, s27, 4096
  buffer_load_dwordx4 v3, s[12:15], s27 offen lds
  s_add_u32 s4, s16, 0x1618000
  s_addc_u32 s5, s17, 0
  s_mov_b32 s6, 0xc8000
  s_mov_b32 s7, 0x00020000
  s_add_u32 s8, s16, 0x1c0a000
  s_addc_u32 s9, s17, 0
  s_mov_b32 s10, 0xa00
  s_mov_b32 s11, 0x00020000
  buffer_load_dwordx4 a[0:3], v3, s[4:7], s31 offen offset:0
  buffer_load_dwordx4 a[4:7], v3, s[4:7], s31 offen offset:1024
  s_add_u32 s31, s31, 10240
  v_cndmask_b32 v58, 0, v58, vcc
  v_cndmask_b32 v59, 0, v59, s[34:35]
  v_cndmask_b32 v60, 0, v60, vcc
  v_cndmask_b32 v61, 0, v61, vcc
  v_cndmask_b32 v62, 0, v62, vcc
  v_cndmask_b32 v63, 0, v63, s[34:35]
  v_mul_u32_u24 v6, 80, v2
  v_add_u32 v6, v6, v1
  v_lshl_add_u32 v112, v6, 2, s25
  v_add_u32 v96, 0, v6
  v_bfe_u32 v5, v96, 1, 3
  v_xor_b32 v5, s20, v5
  v_lshlrev_b32 v96, 7, v96
  v_lshl_add_u32 v96, v5, 4, v96
  v_add_u32 v97, 20, v6
  v_bfe_u32 v5, v97, 1, 3
  v_xor_b32 v5, s20, v5
  v_lshlrev_b32 v97, 7, v97
  v_lshl_add_u32 v97, v5, 4, v97
  v_add_u32 v98, 40, v6
  v_bfe_u32 v5, v98, 1, 3
  v_xor_b32 v5, s20, v5
  v_lshlrev_b32 v98, 7, v98
  v_lshl_add_u32 v98, v5, 4, v98
  v_add_u32 v99, 60, v6
  v_bfe_u32 v5, v99, 1, 3
  v_xor_b32 v5, s20, v5
  v_lshlrev_b32 v99, 7, v99
  v_lshl_add_u32 v99, v5, 4, v99
  v_sub_u32 v6, 260, v6
  v_add_u32 v100, 0, v6
  v_bfe_u32 v5, v100, 1, 3
  v_xor_b32 v5, s20, v5
  v_lshlrev_b32 v100, 7, v100
  v_lshl_add_u32 v100, v5, 4, v100
  v_add_u32 v101, 20, v6
  v_bfe_u32 v5, v101, 1, 3
  v_xor_b32 v5, s20, v5
  v_lshlrev_b32 v101, 7, v101
  v_lshl_add_u32 v101, v5, 4, v101
  v_add_u32 v102, 40, v6
  v_bfe_u32 v5, v102, 1, 3
  v_xor_b32 v5, s20, v5
  v_lshlrev_b32 v102, 7, v102
  v_lshl_add_u32 v102, v5, 4, v102
  v_add_u32 v103, 60, v6
  v_bfe_u32 v5, v103, 1, 3
  v_xor_b32 v5, s20, v5
  v_lshlrev_b32 v103, 7, v103
  v_lshl_add_u32 v103, v5, 4, v103
  v_mul_u32_u24 v152, 10560, v2
  v_lshrrev_b32 v5, 2, v1
  v_mul_u32_u24 v5, 272, v5
  v_add_u32 v152, v152, v5
  v_and_b32 v5, 3, v1
  v_lshl_add_u32 v152, v5, 2, v152
  s_lshl_b32 s34, s30, 10
  s_lshl_b32 s35, s29, 6
  s_add_u32 s34, s34, s35
  s_add_u32 s34, s34, 90112
  v_add_u32 v152, s34, v152
  v_xor_b32 v153, 16, v152
  v_xor_b32 v154, 32, v152
  v_xor_b32 v155, 48, v152
  s_mov_b32 s36, 0xffff0000
  s_mov_b32 s37, 0x3f803f80
  buffer_load_dwordx4 a[8:11], v3, s[4:7], s32 offen offset:0
  s_add_u32 s32, s32, 10240
  buffer_load_dwordx4 a[12:15], v3, s[4:7], s31 offen offset:0
  s_waitcnt vmcnt(9)
  s_barrier
  ds_read_b128 v[64:67], v96 offset:0
  ds_read_b128 v[68:71], v97 offset:0
  ds_read_b128 v[72:75], v98 offset:0
  ds_read_b128 v[76:79], v99 offset:0
  ds_read_b128 v[80:83], v100 offset:0
  ds_read_b128 v[84:87], v101 offset:0
  ds_read_b128 v[88:91], v102 offset:0
  ds_read_b128 v[92:95], v103 offset:0
  buffer_load_dwordx4 a[16:19], v3, s[4:7], s31 offen offset:1024
  s_add_u32 s31, s31, 10240
  s_waitcnt vmcnt(5)
  ds_read_b32 v128, v112 offset:0
  ds_read_b32 v129, v112 offset:64
  ds_read_b32 v130, v112 offset:128
  ds_read_b32 v131, v112 offset:192
  ds_read_b32 v132, v112 offset:256
  ds_read_b32 v134, v112 offset:1280
  ds_read_b32 v135, v112 offset:1344
  ds_read_b32 v136, v112 offset:1408
  ds_read_b32 v137, v112 offset:1472
  ds_read_b32 v138, v112 offset:1536
  ds_read_b32 v140, v112 offset:2560
  ds_read_b32 v141, v112 offset:2624
  ds_read_b32 v142, v112 offset:2688
  ds_read_b32 v143, v112 offset:2752
  ds_read_b32 v144, v112 offset:2816
  ds_read_b32 v146, v112 offset:3840
  ds_read_b32 v147, v112 offset:3904
  ds_read_b32 v148, v112 offset:3968
  ds_read_b32 v149, v112 offset:4032
  ds_read_b32 v150, v112 offset:4096
  s_waitcnt lgkmcnt(15)
  v_swap_b32 v65, v68
  v_swap_b32 v66, v72
  v_swap_b32 v67, v76
  v_swap_b32 v70, v73
  v_swap_b32 v71, v77
  v_swap_b32 v75, v78
  v_swap_b32 v81, v84
  v_swap_b32 v82, v88
  v_swap_b32 v83, v92
  v_swap_b32 v86, v89
  v_swap_b32 v87, v93
  v_swap_b32 v91, v94
  v_mfma_f32_16x16x32_bf16 v[96:99], v[64:67], v[8:11], 0
  v_mfma_f32_16x16x32_bf16 v[100:103], v[64:67], v[12:15], 0
  v_mfma_f32_16x16x32_bf16 v[104:107], v[64:67], v[16:19], 0
  v_mfma_f32_16x16x32_bf16 v[108:111], v[64:67], v[20:23], 0
  buffer_load_dwordx4 a[20:23], v3, s[4:7], s32 offen offset:0
  s_add_u32 s32, s32, 10240
  v_mfma_f32_16x16x32_bf16 v[96:99], v[80:83], v[24:27], v[96:99]
  v_mfma_f32_16x16x32_bf16 v[100:103], v[80:83], v[28:31], v[100:103]
  v_mfma_f32_16x16x32_bf16 v[104:107], v[80:83], v[32:35], v[104:107]
  v_mfma_f32_16x16x32_bf16 v[108:111], v[80:83], v[36:39], v[108:111]
  buffer_load_dwordx4 a[24:27], v3, s[4:7], s31 offen offset:0
  v_mfma_f32_16x16x32_bf16 v[112:115], v[68:71], v[8:11], 0
  v_mfma_f32_16x16x32_bf16 v[116:119], v[68:71], v[12:15], 0
  v_mfma_f32_16x16x32_bf16 v[120:123], v[68:71], v[16:19], 0
  v_mfma_f32_16x16x32_bf16 v[124:127], v[68:71], v[20:23], 0
  buffer_load_dwordx4 a[28:31], v3, s[4:7], s31 offen offset:1024
  s_add_u32 s31, s31, 10240
  v_mfma_f32_16x16x32_bf16 v[112:115], v[84:87], v[24:27], v[112:115]
  v_mfma_f32_16x16x32_bf16 v[116:119], v[84:87], v[28:31], v[116:119]
  v_mfma_f32_16x16x32_bf16 v[120:123], v[84:87], v[32:35], v[120:123]
  v_mfma_f32_16x16x32_bf16 v[124:127], v[84:87], v[36:39], v[124:127]
  buffer_load_dwordx4 a[32:35], v3, s[4:7], s32 offen offset:0
  s_add_u32 s32, s32, 10240
  v_pk_mul_f32 v[156:157], v[100:101], v[44:45]
  v_pk_mul_f32 v[160:161], v[96:97], v[44:45]
  v_pk_mul_f32 v[158:159], v[102:103], v[46:47]
  v_pk_mul_f32 v[162:163], v[98:99], v[46:47]
  v_pk_fma_f32 v[96:97], v[96:97], v[40:41], v[156:157]
  v_pk_fma_f32 v[100:101], v[100:101], v[40:41], v[160:161] neg_lo:[0,0,1] neg_hi:[0,0,1]
  v_pk_fma_f32 v[98:99], v[98:99], v[42:43], v[158:159]
  v_pk_fma_f32 v[102:103], v[102:103], v[42:43], v[162:163] neg_lo:[0,0,1] neg_hi:[0,0,1]
  v_cvt_pk_bf16_f32 v64, v96, v100
  v_cvt_pk_bf16_f32 v65, v97, v101
  v_cvt_pk_bf16_f32 v66, v98, v102
  v_cvt_pk_bf16_f32 v67, v99, v103
  v_lshlrev_b32 v96, 16, v128
  v_lshlrev_b32 v97, 16, v129
  v_lshlrev_b32 v98, 16, v130
  v_lshlrev_b32 v99, 16, v131
  v_lshlrev_b32 v100, 16, v132
  s_nop 0
  v_mfma_f32_16x16x32_bf16 v[96:99], v[56:59], v[64:67], v[96:99]
  v_mfma_f32_16x16x32_bf16 v[100:103], v[60:63], v[64:67], v[100:103]
  buffer_load_dwordx4 a[36:39], v3, s[4:7], s31 offen offset:0
  v_pk_mul_f32 v[156:157], v[108:109], v[52:53]
  v_pk_mul_f32 v[160:161], v[104:105], v[52:53]
  v_pk_mul_f32 v[158:159], v[110:111], v[54:55]
  v_pk_mul_f32 v[162:163], v[106:107], v[54:55]
  v_pk_fma_f32 v[104:105], v[104:105], v[48:49], v[156:157]
  v_pk_fma_f32 v[108:109], v[108:109], v[48:49], v[160:161] neg_lo:[0,0,1] neg_hi:[0,0,1]
  v_pk_fma_f32 v[106:107], v[106:107], v[50:51], v[158:159]
  v_pk_fma_f32 v[110:111], v[110:111], v[50:51], v[162:163] neg_lo:[0,0,1] neg_hi:[0,0,1]
  v_cvt_pk_bf16_f32 v80, v104, v108
  v_cvt_pk_bf16_f32 v81, v105, v109
  v_cvt_pk_bf16_f32 v82, v106, v110
  v_cvt_pk_bf16_f32 v83, v107, v111
  v_and_b32 v104, s36, v128
  v_and_b32 v105, s36, v129
  v_and_b32 v106, s36, v130
  v_and_b32 v107, s36, v131
  v_and_b32 v108, s36, v132
  s_nop 0
  v_mfma_f32_16x16x32_bf16 v[104:107], v[56:59], v[80:83], v[104:107]
  v_mfma_f32_16x16x32_bf16 v[108:111], v[60:63], v[80:83], v[108:111]
  buffer_load_dwordx4 a[40:43], v3, s[4:7], s31 offen offset:1024
  s_add_u32 s31, s31, 10240
  v_pk_mul_f32 v[156:157], v[116:117], v[44:45]
  v_pk_mul_f32 v[160:161], v[112:113], v[44:45]
  v_pk_mul_f32 v[158:159], v[118:119], v[46:47]
  v_pk_mul_f32 v[162:163], v[114:115], v[46:47]
  v_pk_fma_f32 v[112:113], v[112:113], v[40:41], v[156:157]
  v_pk_fma_f32 v[116:117], v[116:117], v[40:41], v[160:161] neg_lo:[0,0,1] neg_hi:[0,0,1]
  v_pk_fma_f32 v[114:115], v[114:115], v[42:43], v[158:159]
  v_pk_fma_f32 v[118:119], v[118:119], v[42:43], v[162:163] neg_lo:[0,0,1] neg_hi:[0,0,1]
  v_cvt_pk_bf16_f32 v68, v112, v116
  v_cvt_pk_bf16_f32 v69, v113, v117
  v_cvt_pk_bf16_f32 v70, v114, v118
  v_cvt_pk_bf16_f32 v71, v115, v119
  s_waitcnt lgkmcnt(14)
  v_lshlrev_b32 v112, 16, v134
  s_waitcnt lgkmcnt(13)
  v_lshlrev_b32 v113, 16, v135
  s_waitcnt lgkmcnt(12)
  v_lshlrev_b32 v114, 16, v136
  s_waitcnt lgkmcnt(11)
  v_lshlrev_b32 v115, 16, v137
  s_waitcnt lgkmcnt(10)
  v_lshlrev_b32 v116, 16, v138
  v_mfma_f32_16x16x32_bf16 v[112:115], v[56:59], v[68:71], v[112:115]
  s_nop 0
  v_mfma_f32_16x16x32_bf16 v[116:119], v[60:63], v[68:71], v[116:119]
  buffer_load_dwordx4 a[44:47], v3, s[4:7], s32 offen offset:0
  s_add_u32 s32, s32, 10240
  v_pk_mul_f32 v[156:157], v[124:125], v[52:53]
  v_pk_mul_f32 v[160:161], v[120:121], v[52:53]
  v_pk_mul_f32 v[158:159], v[126:127], v[54:55]
  v_pk_mul_f32 v[162:163], v[122:123], v[54:55]
  v_pk_fma_f32 v[120:121], v[120:121], v[48:49], v[156:157]
  v_pk_fma_f32 v[124:125], v[124:125], v[48:49], v[160:161] neg_lo:[0,0,1] neg_hi:[0,0,1]
  v_pk_fma_f32 v[122:123], v[122:123], v[50:51], v[158:159]
  v_pk_fma_f32 v[126:127], v[126:127], v[50:51], v[162:163] neg_lo:[0,0,1] neg_hi:[0,0,1]
  v_cvt_pk_bf16_f32 v84, v120, v124
  v_cvt_pk_bf16_f32 v85, v121, v125
  v_cvt_pk_bf16_f32 v86, v122, v126
  v_cvt_pk_bf16_f32 v87, v123, v127
  v_and_b32 v120, s36, v134
  v_and_b32 v121, s36, v135
  v_and_b32 v122, s36, v136
  v_and_b32 v123, s36, v137
  v_and_b32 v124, s36, v138
  s_nop 0
  v_mfma_f32_16x16x32_bf16 v[120:123], v[56:59], v[84:87], v[120:123]
  v_mfma_f32_16x16x32_bf16 v[124:127], v[60:63], v[84:87], v[124:127]
  buffer_load_dwordx4 a[48:51], v3, s[4:7], s31 offen offset:0
  v_cvt_pk_bf16_f32 v128, v96, v104
  v_cvt_pk_bf16_f32 v129, v97, v105
  v_cvt_pk_bf16_f32 v130, v98, v106
  v_cvt_pk_bf16_f32 v131, v99, v107
  v_cvt_pk_bf16_f32 v132, v100, v108
  ds_write_b32 v152, v128 offset:0
  ds_write_b32 v152, v129 offset:2112
  ds_write_b32 v152, v130 offset:4224
  ds_write_b32 v152, v131 offset:6336
  ds_write_b32 v152, v132 offset:8448
  v_mfma_f32_16x16x32_bf16 v[96:99], v[72:75], v[8:11], 0
  v_mfma_f32_16x16x32_bf16 v[100:103], v[72:75], v[12:15], 0
  v_mfma_f32_16x16x32_bf16 v[104:107], v[72:75], v[16:19], 0
  v_mfma_f32_16x16x32_bf16 v[108:111], v[72:75], v[20:23], 0
  buffer_load_dwordx4 a[52:55], v3, s[4:7], s31 offen offset:1024
  s_add_u32 s31, s31, s33
  v_mfma_f32_16x16x32_bf16 v[96:99], v[88:91], v[24:27], v[96:99]
  v_mfma_f32_16x16x32_bf16 v[100:103], v[88:91], v[28:31], v[100:103]
  v_mfma_f32_16x16x32_bf16 v[104:107], v[88:91], v[32:35], v[104:107]
  v_mfma_f32_16x16x32_bf16 v[108:111], v[88:91], v[36:39], v[108:111]
  buffer_load_dwordx4 a[56:59], v3, s[4:7], s32 offen offset:0
  v_cvt_pk_bf16_f32 v134, v112, v120
  v_cvt_pk_bf16_f32 v135, v113, v121
  v_cvt_pk_bf16_f32 v136, v114, v122
  v_cvt_pk_bf16_f32 v137, v115, v123
  v_cvt_pk_bf16_f32 v138, v116, v124
  ds_write_b32 v153, v134 offset:0
  ds_write_b32 v153, v135 offset:2112
  ds_write_b32 v153, v136 offset:4224
  ds_write_b32 v153, v137 offset:6336
  ds_write_b32 v153, v138 offset:8448
  v_mfma_f32_16x16x32_bf16 v[112:115], v[76:79], v[8:11], 0
  v_mfma_f32_16x16x32_bf16 v[116:119], v[76:79], v[12:15], 0
  v_mfma_f32_16x16x32_bf16 v[120:123], v[76:79], v[16:19], 0
  v_mfma_f32_16x16x32_bf16 v[124:127], v[76:79], v[20:23], 0
  buffer_load_dwordx4 a[60:63], v3, s[4:7], s31 offen offset:0
  v_mfma_f32_16x16x32_bf16 v[112:115], v[92:95], v[24:27], v[112:115]
  v_mfma_f32_16x16x32_bf16 v[116:119], v[92:95], v[28:31], v[116:119]
  v_mfma_f32_16x16x32_bf16 v[120:123], v[92:95], v[32:35], v[120:123]
  v_mfma_f32_16x16x32_bf16 v[124:127], v[92:95], v[36:39], v[124:127]
  buffer_load_dwordx4 a[64:67], v3, s[4:7], s31 offen offset:1024
  s_add_u32 s31, s31, 10240
  v_pk_mul_f32 v[156:157], v[100:101], v[44:45]
  v_pk_mul_f32 v[160:161], v[96:97], v[44:45]
  v_pk_mul_f32 v[158:159], v[102:103], v[46:47]
  v_pk_mul_f32 v[162:163], v[98:99], v[46:47]
  v_pk_fma_f32 v[96:97], v[96:97], v[40:41], v[156:157]
  v_pk_fma_f32 v[100:101], v[100:101], v[40:41], v[160:161] neg_lo:[0,0,1] neg_hi:[0,0,1]
  v_pk_fma_f32 v[98:99], v[98:99], v[42:43], v[158:159]
  v_pk_fma_f32 v[102:103], v[102:103], v[42:43], v[162:163] neg_lo:[0,0,1] neg_hi:[0,0,1]
  v_cvt_pk_bf16_f32 v72, v96, v100
  v_cvt_pk_bf16_f32 v73, v97, v101
  v_cvt_pk_bf16_f32 v74, v98, v102
  v_cvt_pk_bf16_f32 v75, v99, v103
  s_waitcnt lgkmcnt(15)
  v_lshlrev_b32 v96, 16, v140
  v_lshlrev_b32 v97, 16, v141
  v_lshlrev_b32 v98, 16, v142
  v_lshlrev_b32 v99, 16, v143
  v_lshlrev_b32 v100, 16, v144
  s_nop 0
  v_mfma_f32_16x16x32_bf16 v[96:99], v[56:59], v[72:75], v[96:99]
  v_mfma_f32_16x16x32_bf16 v[100:103], v[60:63], v[72:75], v[100:103]
  buffer_load_dwordx4 a[68:71], v3, s[4:7], s31 offen offset:0
  v_pk_mul_f32 v[156:157], v[108:109], v[52:53]
  v_pk_mul_f32 v[160:161], v[104:105], v[52:53]
  v_pk_mul_f32 v[158:159], v[110:111], v[54:55]
  v_pk_mul_f32 v[162:163], v[106:107], v[54:55]
  v_pk_fma_f32 v[104:105], v[104:105], v[48:49], v[156:157]
  v_pk_fma_f32 v[108:109], v[108:109], v[48:49], v[160:161] neg_lo:[0,0,1] neg_hi:[0,0,1]
  v_pk_fma_f32 v[106:107], v[106:107], v[50:51], v[158:159]
  v_pk_fma_f32 v[110:111], v[110:111], v[50:51], v[162:163] neg_lo:[0,0,1] neg_hi:[0,0,1]
  v_cvt_pk_bf16_f32 v88, v104, v108
  v_cvt_pk_bf16_f32 v89, v105, v109
  v_cvt_pk_bf16_f32 v90, v106, v110
  v_cvt_pk_bf16_f32 v91, v107, v111
  v_and_b32 v104, s36, v140
  v_and_b32 v105, s36, v141
  v_and_b32 v106, s36, v142
  v_and_b32 v107, s36, v143
  v_and_b32 v108, s36, v144
  s_nop 0
  v_mfma_f32_16x16x32_bf16 v[104:107], v[56:59], v[88:91], v[104:107]
  v_mfma_f32_16x16x32_bf16 v[108:111], v[60:63], v[88:91], v[108:111]
  buffer_load_dwordx4 a[72:75], v3, s[4:7], s31 offen offset:1024
  s_add_u32 s31, s31, 10240
  v_pk_mul_f32 v[156:157], v[116:117], v[44:45]
  v_pk_mul_f32 v[160:161], v[112:113], v[44:45]
  v_pk_mul_f32 v[158:159], v[118:119], v[46:47]
  v_pk_mul_f32 v[162:163], v[114:115], v[46:47]
  v_pk_fma_f32 v[112:113], v[112:113], v[40:41], v[156:157]
  v_pk_fma_f32 v[116:117], v[116:117], v[40:41], v[160:161] neg_lo:[0,0,1] neg_hi:[0,0,1]
  v_pk_fma_f32 v[114:115], v[114:115], v[42:43], v[158:159]
  v_pk_fma_f32 v[118:119], v[118:119], v[42:43], v[162:163] neg_lo:[0,0,1] neg_hi:[0,0,1]
  v_cvt_pk_bf16_f32 v76, v112, v116
  v_cvt_pk_bf16_f32 v77, v113, v117
  v_cvt_pk_bf16_f32 v78, v114, v118
  v_cvt_pk_bf16_f32 v79, v115, v119
  s_waitcnt lgkmcnt(14)
  v_lshlrev_b32 v112, 16, v146
  s_waitcnt lgkmcnt(13)
  v_lshlrev_b32 v113, 16, v147
  s_waitcnt lgkmcnt(12)
  v_lshlrev_b32 v114, 16, v148
  s_waitcnt lgkmcnt(11)
  v_lshlrev_b32 v115, 16, v149
  s_waitcnt lgkmcnt(10)
  v_lshlrev_b32 v116, 16, v150
  v_mfma_f32_16x16x32_bf16 v[112:115], v[56:59], v[76:79], v[112:115]
  s_nop 0
  v_mfma_f32_16x16x32_bf16 v[116:119], v[60:63], v[76:79], v[116:119]
  buffer_load_dwordx4 a[76:79], v3, s[4:7], s31 offen offset:0
  v_pk_mul_f32 v[156:157], v[124:125], v[52:53]
  v_pk_mul_f32 v[160:161], v[120:121], v[52:53]
  v_pk_mul_f32 v[158:159], v[126:127], v[54:55]
  v_pk_mul_f32 v[162:163], v[122:123], v[54:55]
  v_pk_fma_f32 v[120:121], v[120:121], v[48:49], v[156:157]
  v_pk_fma_f32 v[124:125], v[124:125], v[48:49], v[160:161] neg_lo:[0,0,1] neg_hi:[0,0,1]
  v_pk_fma_f32 v[122:123], v[122:123], v[50:51], v[158:159]
  v_pk_fma_f32 v[126:127], v[126:127], v[50:51], v[162:163] neg_lo:[0,0,1] neg_hi:[0,0,1]
  v_cvt_pk_bf16_f32 v92, v120, v124
  v_cvt_pk_bf16_f32 v93, v121, v125
  v_cvt_pk_bf16_f32 v94, v122, v126
  v_cvt_pk_bf16_f32 v95, v123, v127
  v_and_b32 v120, s36, v146
  v_and_b32 v121, s36, v147
  v_and_b32 v122, s36, v148
  v_and_b32 v123, s36, v149
  v_and_b32 v124, s36, v150
  s_nop 0
  v_mfma_f32_16x16x32_bf16 v[120:123], v[56:59], v[92:95], v[120:123]
  v_mfma_f32_16x16x32_bf16 v[124:127], v[60:63], v[92:95], v[124:127]
  buffer_load_dwordx4 v[8:11], v3, s[4:7], s31 offen offset:1024
  s_add_u32 s31, s31, 10240
  s_mul_i32 s34, s22, 640
  s_lshl_b32 s35, s29, 7
  s_add_u32 s35, s35, s34
  s_lshl_b32 s38, s19, 6
  s_add_u32 s34, s34, s38
  v_lshlrev_b32 v5, 4, v2
  buffer_load_dwordx4 v[28:31], v5, s[8:11], s35 offen
  buffer_load_dwordx4 v[32:35], v5, s[8:11], s35 offen offset:64
  buffer_load_dwordx4 v[36:39], v5, s[8:11], s34 offen offset:512
  v_xor_b32 v5, v1, v2
  v_lshlrev_b32 v5, 4, v5
  v_lshl_add_u32 v5, v2, 8, v5
  s_lshl_b32 s35, s55, 10
  s_xor_b32 s34, s54, 0
  s_mul_i32 s34, s34, 10560
  s_add_u32 s34, s34, 90112
  s_add_u32 s38, s34, s35
  v_add_u32 v4, s38, v5
  s_sub_u32 s38, s34, s35
  s_add_u32 s38, s38, 1024
  v_add_u32 v6, s38, v5
  s_xor_b32 s34, s54, 1
  s_mul_i32 s34, s34, 10560
  s_add_u32 s34, s34, 90112
  s_add_u32 s38, s34, s35
  v_add_u32 v156, s38, v5
  s_sub_u32 s38, s34, s35
  s_add_u32 s38, s38, 1024
  v_add_u32 v157, s38, v5
  s_cmp_gt_u32 s20, 4
  s_cselect_b32 s34, 5, 0
  s_cselect_b32 s35, 1024, 0
  s_mul_i32 s38, s22, 5
  s_add_u32 s38, s38, s20
  s_sub_u32 s34, s38, s34
  s_mul_i32 s39, s34, 2112
  s_add_u32 s39, s39, s35
  s_add_u32 s39, s39, 90112
  v_add_u32 v158, s39, v5
  s_lshl_b32 s34, s34, 17
  s_lshl_b32 s39, s21, 11
  s_add_u32 s50, s34, s39
  s_add_u32 s50, s50, s35
  s_mul_i32 s38, s22, 5
  s_add_u32 s38, s38, s18
  s_add_u32 s38, s38, 3
  s_mul_i32 s34, s38, 2112
  s_add_u32 s34, s34, 91136
  v_add_u32 v159, s34, v5
  s_lshl_b32 s38, s38, 17
  s_add_u32 s51, s38, s39
  s_add_u32 s51, s51, 1024
  s_cmp_gt_u32 s20, 1
  s_cselect_b32 s51, 0x40000000, s51
  v_cvt_pk_bf16_f32 v140, v96, v104
  v_cvt_pk_bf16_f32 v141, v97, v105
  v_cvt_pk_bf16_f32 v142, v98, v106
  v_cvt_pk_bf16_f32 v143, v99, v107
  v_cvt_pk_bf16_f32 v144, v100, v108
  ds_write_b32 v154, v140 offset:0
  ds_write_b32 v154, v141 offset:2112
  ds_write_b32 v154, v142 offset:4224
  ds_write_b32 v154, v143 offset:6336
  ds_write_b32 v154, v144 offset:8448
  v_cvt_pk_bf16_f32 v146, v112, v120
  v_cvt_pk_bf16_f32 v147, v113, v121
  v_cvt_pk_bf16_f32 v148, v114, v122
  v_cvt_pk_bf16_f32 v149, v115, v123
  v_cvt_pk_bf16_f32 v150, v116, v124
  ds_write_b32 v155, v146 offset:0
  ds_write_b32 v155, v147 offset:2112
  ds_write_b32 v155, v148 offset:4224
  ds_write_b32 v155, v149 offset:6336
  ds_write_b32 v155, v150 offset:8448
  buffer_load_dwordx4 v[12:15], v3, s[4:7], s31 offen offset:0
  buffer_load_dwordx4 v[16:19], v3, s[4:7], s31 offen offset:1024
  s_add_u32 s31, s31, 10240
  s_waitcnt lgkmcnt(0)
  s_barrier
  ds_read_b128 v[64:67], v4 offset:0
  ds_read_b128 v[68:71], v6 offset:0
  ds_read_b128 v[72:75], v4 offset:2112
  ds_read_b128 v[76:79], v6 offset:2112
  ds_read_b128 v[80:83], v4 offset:4224
  ds_read_b128 v[84:87], v6 offset:4224
  ds_read_b128 v[104:107], v158
  ds_read_b128 v[108:111], v159
  v_mov_b32 v160, s37
  v_mov_b32 v161, s37
  v_mov_b32 v162, s37
  v_mov_b32 v163, s37
  buffer_load_dwordx4 v[20:23], v3, s[4:7], s31 offen offset:0
  buffer_load_dwordx4 v[24:27], v3, s[4:7], s31 offen offset:1024
  s_add_u32 s12, s16, 0xa12000
  s_addc_u32 s13, s17, 0
  s_mov_b32 s14, 0x4000
  s_mov_b32 s15, 0x00020000
  s_add_u32 s8, s16, 0x792000
  s_addc_u32 s9, s17, 0
  s_mov_b32 s10, 0x280000
  s_mov_b32 s11, 0x00020000
  s_add_u32 s44, s16, 0xa16000
  s_addc_u32 s45, s17, 0
  s_mov_b32 s46, 0x281400
  s_mov_b32 s47, 0x00020000
  s_waitcnt lgkmcnt(7)
  v_mfma_f32_16x16x32_bf16 v[100:103], v[64:67], v[64:67], 0
  ds_read_b128 v[88:91], v4 offset:6336
  v_mfma_f32_16x16x32_bf16 v[96:99], v[160:163], v[64:67], 0
  ds_read_b128 v[92:95], v6 offset:6336
  s_lshl_b32 s34, s20, 11
  s_waitcnt vmcnt(25)
  v_mfma_f32_16x16x32_bf16 v[56:59], a[8:11], v[64:67], 0
  s_add_u32 s34, s34, 147456
  v_add_u32 v152, s34, v3
  s_waitcnt lgkmcnt(8)
  v_mfma_f32_16x16x32_bf16 v[60:63], a[8:11], v[68:71], 0
  s_lshl_b32 s34, s18, 13
  s_lshl_b32 s35, s54, 10
  v_mfma_f32_16x16x32_bf16 v[48:51], a[0:3], v[68:71], 0
  s_add_u32 s34, s34, s35
  s_lshl_b32 s38, s55, 12
  v_mfma_f32_16x16x32_bf16 v[52:55], a[4:7], v[68:71], 0
  s_add_u32 s34, s34, s38
  v_add_u32 v153, s34, v3
  v_mfma_f32_16x16x32_bf16 v[40:43], a[0:3], v[64:67], 0
  v_xor_b32 v147, 0x1000, v153
  s_lshl_b32 s38, s55, 13
  v_mfma_f32_16x16x32_bf16 v[44:47], a[4:7], v[64:67], 0
  s_add_u32 s34, s35, s38
  v_add_u32 v154, s34, v3
  v_lshlrev_b32 v5, 6, v1
  v_lshl_add_u32 v144, v2, 3, v5
  s_waitcnt lgkmcnt(7)
  v_mfma_f32_16x16x32_bf16 v[100:103], v[72:75], v[72:75], v[100:103]
  ds_read_b128 v[64:67], v4 offset:8448
  v_mfma_f32_16x16x32_bf16 v[96:99], v[160:163], v[72:75], v[96:99]
  ds_read_b128 v[68:71], v6 offset:8448
  s_waitcnt lgkmcnt(5)
  buffer_store_dwordx4 v[104:107], v3, s[8:11], s50 offen sc1
  s_waitcnt vmcnt(23)
  v_mfma_f32_16x16x32_bf16 v[56:59], a[20:23], v[72:75], v[56:59]
  s_waitcnt lgkmcnt(4)
  buffer_store_dwordx4 v[108:111], v3, s[8:11], s51 offen sc1
  v_lshl_add_u32 v155, v2, 4, v5
  v_mfma_f32_16x16x32_bf16 v[60:63], a[20:23], v[76:79], v[60:63]
  v_lshrrev_b32 v145, 2, v1
  v_lshl_add_u32 v145, v145, 4, v1
  v_and_b32 v5, 3, v1
  v_mfma_f32_16x16x32_bf16 v[48:51], a[12:15], v[76:79], v[48:51]
  v_lshl_add_u32 v145, v145, 2, v5
  s_add_u32 s38, s38, 32768
  v_mfma_f32_16x16x32_bf16 v[52:55], a[16:19], v[76:79], v[52:55]
  v_lshl_add_u32 v145, v145, 2, s38
  v_lshlrev_b32 v146, 28, v2
  v_mfma_f32_16x16x32_bf16 v[40:43], a[12:15], v[72:75], v[40:43]
  v_lshl_add_u32 v146, v1, 3, v146
  s_lshl_b32 s53, s21, 1
  s_add_u32 s53, s53, s55
  v_mfma_f32_16x16x32_bf16 v[44:47], a[16:19], v[72:75], v[44:47]
  s_lshl_b32 s53, s53, 7
  s_lshl_b32 s38, s22, 2
  s_lshr_b32 s38, 0x0413, s38
  s_and_b32 s38, s38, 15
  v_mfma_f32_16x16x32_bf16 v[100:103], v[80:83], v[80:83], v[100:103]
  ds_read_b128 v[72:75], v157 offset:0
  v_mfma_f32_16x16x32_bf16 v[96:99], v[160:163], v[80:83], v[96:99]
  ds_read_b128 v[76:79], v157 offset:2112
  s_lshl_b32 s39, s21, 5
  s_waitcnt vmcnt(21)
  v_mfma_f32_16x16x32_bf16 v[56:59], a[32:35], v[80:83], v[56:59]
  s_add_u32 s38, s38, s39
  s_lshl_b32 s39, s55, 4
  v_mfma_f32_16x16x32_bf16 v[60:63], a[32:35], v[84:87], v[60:63]
  s_add_u32 s38, s38, s39
  s_mul_i32 s39, s22, 10260
  v_mfma_f32_16x16x32_bf16 v[48:51], a[24:27], v[84:87], v[48:51]
  s_add_u32 s38, s38, s39
  s_mul_i32 s40, s29, 2052
  v_mfma_f32_16x16x32_bf16 v[52:55], a[28:31], v[84:87], v[52:55]
  s_add_u32 s40, s40, s38
  s_lshl_b32 s40, s40, 6
  v_mfma_f32_16x16x32_bf16 v[40:43], a[24:27], v[80:83], v[40:43]
  s_add_u32 s41, s38, 8208
  s_lshl_b32 s41, s41, 6
  v_mfma_f32_16x16x32_bf16 v[44:47], a[28:31], v[80:83], v[44:47]
  s_lshl_b32 s42, s19, 5
  s_add_u32 s41, s41, s42
  s_lshl_b32 s43, s19, 13
  s_lshl_b32 s42, s55, 12
  s_waitcnt lgkmcnt(5)
  v_mfma_f32_16x16x32_bf16 v[100:103], v[88:91], v[88:91], v[100:103]
  ds_read_b128 v[80:83], v157 offset:4224
  v_mfma_f32_16x16x32_bf16 v[96:99], v[160:163], v[88:91], v[96:99]
  ds_read_b128 v[84:87], v157 offset:6336
  s_add_u32 s43, s43, s42
  s_waitcnt vmcnt(18)
  v_mfma_f32_16x16x32_bf16 v[56:59], a[44:47], v[88:91], v[56:59]
  v_lshlrev_b32 v7, 22, v3
  s_and_b32 s63, s2, 1
  s_waitcnt lgkmcnt(6)
  v_mfma_f32_16x16x32_bf16 v[60:63], a[44:47], v[92:95], v[60:63]
  s_lshl_b32 s63, s63, 2
  s_lshr_b32 s62, s2, 6
  v_mfma_f32_16x16x32_bf16 v[48:51], a[36:39], v[92:95], v[48:51]
  s_add_u32 s63, s63, s62
  s_mul_i32 s63, s63, 102400
  v_mfma_f32_16x16x32_bf16 v[52:55], a[40:43], v[92:95], v[52:55]
  s_add_u32 s63, s63, s24
  s_mov_b32 s26, s24
  v_mfma_f32_16x16x32_bf16 v[40:43], a[36:39], v[88:91], v[40:43]
  s_add_u32 s56, s16, 0x1c0b000
  s_addc_u32 s57, s17, 0
  v_mfma_f32_16x16x32_bf16 v[44:47], a[40:43], v[88:91], v[44:47]
  s_mov_b32 s58, 0x3000
  s_mov_b32 s59, 0x00020000
  s_lshl_b32 s61, s21, 7
  s_waitcnt lgkmcnt(5)
  v_mfma_f32_16x16x32_bf16 v[100:103], v[64:67], v[64:67], v[100:103]
  ds_read_b128 v[88:91], v157 offset:8448
  v_mfma_f32_16x16x32_bf16 v[96:99], v[160:163], v[64:67], v[96:99]
  s_waitcnt vmcnt(15)
  v_mfma_f32_16x16x32_bf16 v[56:59], a[56:59], v[64:67], v[56:59]
  s_waitcnt lgkmcnt(5)
  v_mfma_f32_16x16x32_bf16 v[60:63], a[56:59], v[68:71], v[60:63]
  ds_read_b128 v[92:95], v156 offset:0
  v_mfma_f32_16x16x32_bf16 v[48:51], a[48:51], v[68:71], v[48:51]
  v_mfma_f32_16x16x32_bf16 v[52:55], a[52:55], v[68:71], v[52:55]
  ds_write_b128 v154, v[100:103] offset:36864
  ds_write_b128 v154, v[96:99] offset:32768
  v_mfma_f32_16x16x32_bf16 v[40:43], a[48:51], v[64:67], v[40:43]
  ds_write_b128 v153, v[56:59] offset:16384
  v_mfma_f32_16x16x32_bf16 v[44:47], a[52:55], v[64:67], v[44:47]
  ds_write_b128 v147, v[60:63] offset:16384
  v_add_u32 v153, s43, v3
  s_waitcnt lgkmcnt(0)
  s_barrier
  ds_read2st64_b32 v[96:97], v145 offset0:0 offset1:4
  ds_read2st64_b32 v[98:99], v145 offset0:8 offset1:12
  ds_read2st64_b32 v[100:101], v145 offset0:16 offset1:20
  ds_read2st64_b32 v[102:103], v145 offset0:24 offset1:28
  s_add_u32 s4, s16, 0x16e0000
  s_addc_u32 s5, s17, 0
  s_mov_b32 s6, 0xc8000
  s_mov_b32 s7, 0x00020000
  s_waitcnt vmcnt(14)
  v_mfma_f32_16x16x32_bf16 v[48:51], a[60:63], v[72:75], v[48:51]
  ds_read_b128 v[64:67], v156 offset:2112
  s_waitcnt vmcnt(13)
  v_mfma_f32_16x16x32_bf16 v[52:55], a[64:67], v[72:75], v[52:55]
  ds_read_b128 v[68:71], v156 offset:4224
  s_add_u32 m0, s26, 0
  s_add_u32 s62, s63, 0
  buffer_load_dwordx4 v3, s[4:7], s62 offen lds
  s_waitcnt vmcnt(13)
  v_mfma_f32_16x16x32_bf16 v[48:51], a[68:71], v[76:79], v[48:51]
  ds_read_b128 v[112:115], v153 offset:16384
  ds_read_b128 v[116:119], v153 offset:17408
  s_waitcnt vmcnt(12)
  v_mfma_f32_16x16x32_bf16 v[52:55], a[72:75], v[76:79], v[52:55]
  s_add_u32 m0, s26, 8192
  s_add_u32 s62, s63, 8192
  buffer_load_dwordx4 v3, s[4:7], s62 offen lds
  ds_read_b128 v[120:123], v153 offset:18432
  ds_read_b128 v[124:127], v153 offset:19456
  s_waitcnt vmcnt(12)
  v_mfma_f32_16x16x32_bf16 v[48:51], a[76:79], v[80:83], v[48:51]
  ds_read_b128 v[72:75], v156 offset:6336
  s_waitcnt vmcnt(11)
  v_mfma_f32_16x16x32_bf16 v[52:55], v[8:11], v[80:83], v[52:55]
  ds_read_b128 v[76:79], v156 offset:8448
  s_waitcnt lgkmcnt(11)
  v_add_f32 v96, v96, v97
  s_waitcnt lgkmcnt(10)
  v_add_f32 v98, v98, v99
  s_waitcnt vmcnt(7)
  v_mfma_f32_16x16x32_bf16 v[48:51], v[12:15], v[84:87], v[48:51]
  s_waitcnt lgkmcnt(9)
  v_add_f32 v100, v100, v101
  s_add_u32 m0, s26, 49152
  s_add_u32 s62, s63, 49152
  buffer_load_dwordx4 v3, s[4:7], s62 offen lds
  s_waitcnt lgkmcnt(8)
  v_add_f32 v102, v102, v103
  v_add_f32 v96, v96, v98
  s_waitcnt vmcnt(7)
  v_mfma_f32_16x16x32_bf16 v[52:55], v[16:19], v[84:87], v[52:55]
  v_add_f32 v100, v100, v102
  v_mul_f32 v96, 0x3acccccd, v96
  v_mul_f32 v100, 0x3acccccd, v100
  s_add_u32 m0, s26, 57344
  s_add_u32 s62, s63, 57344
  buffer_load_dwordx4 v3, s[4:7], s62 offen lds
  s_waitcnt vmcnt(7)
  v_mfma_f32_16x16x32_bf16 v[48:51], v[20:23], v[88:91], v[48:51]
  v_fma_f32 v100, -v96, v96, v100
  v_max_f32 v100, 0, v100
  v_cvt_pk_bf16_f32 v98, v100, v100
  v_lshlrev_b32 v98, 16, v98
  s_waitcnt vmcnt(6)
  v_mfma_f32_16x16x32_bf16 v[52:55], v[24:27], v[88:91], v[52:55]
  v_cvt_pk_bf16_f32 v97, v96, v96
  s_add_u32 m0, s26, 65536
  s_add_u32 s62, s63, 65536
  buffer_load_dwordx4 v3, s[4:7], s62 offen lds
  v_lshlrev_b32 v97, 16, v97
  v_add_f32 v98, 0x3727c5ac, v98
  v_cvt_pk_bf16_f32 v98, v98, v98
  v_lshlrev_b32 v98, 16, v98
  v_sqrt_f32 v98, v98
  v_mfma_f32_16x16x32_bf16 v[40:43], a[60:63], v[92:95], v[40:43]
  v_sub_f32 v102, v96, v97
  v_mfma_f32_16x16x32_bf16 v[44:47], a[64:67], v[92:95], v[44:47]
  v_cvt_pk_bf16_f32 v103, v98, v98
  v_lshlrev_b32 v103, 16, v103
  s_add_u32 m0, s26, 73728
  s_add_u32 s62, s63, 73728
  buffer_load_dwordx4 v3, s[4:7], s62 offen lds
  v_rcp_f32 v98, v103
  v_mul_f32 v99, -1.0, v97
  v_mul_f32 v101, v100, v98
  ds_write_b128 v152, v[48:51] offset:0
  ds_write_b128 v152, v[52:55] offset:1024
  s_nop 0
  v_xor_b32 v152, 0x2000, v152
  s_waitcnt lgkmcnt(9)
  v_mfma_f32_16x16x32_bf16 v[40:43], a[68:71], v[64:67], v[40:43]
  v_mul_f32 v102, v102, v98
  v_mfma_f32_16x16x32_bf16 v[44:47], a[72:75], v[64:67], v[44:47]
  v_mul_f32 v101, v101, v98
  v_mul_f32 v99, v99, v98
  v_cvt_pk_bf16_f32 v101, v101, v101
  s_waitcnt lgkmcnt(8)
  v_mfma_f32_16x16x32_bf16 v[40:43], a[76:79], v[68:71], v[40:43]
  s_add_u32 m0, s26, 81920
  s_add_u32 s62, s63, 81920
  buffer_load_dwordx4 v3, s[4:7], s62 offen lds
  v_lshlrev_b32 v101, 16, v101
  v_cvt_pk_bf16_f32 v102, v102, v102
  v_lshlrev_b32 v102, 16, v102
  v_add_f32 v101, 0x3727c5ac, v101
  s_waitcnt lgkmcnt(0)
  s_barrier
  ds_read_b128 v[132:135], v152 offset:0
  ds_read_b128 v[136:139], v152 offset:1024
  v_mfma_f32_16x16x32_bf16 v[44:47], v[8:11], v[68:71], v[44:47]
  v_sub_f32 v102, v99, v102
  v_mfma_f32_16x16x32_bf16 v[40:43], v[12:15], v[72:75], v[40:43]
  v_cvt_pk_bf16_f32 v101, v101, v101
  v_lshlrev_b32 v101, 16, v101
  v_mfma_f32_16x16x32_bf16 v[44:47], v[16:19], v[72:75], v[44:47]
  v_sqrt_f32 v101, v101
  v_mul_f32 v128, v102, v103
  v_cvt_pk_bf16_f32 v101, v101, v101
  v_mfma_f32_16x16x32_bf16 v[40:43], v[20:23], v[76:79], v[40:43]
  v_lshlrev_b32 v101, 16, v101
  v_mul_f32 v131, v101, v103
  v_mfma_f32_16x16x32_bf16 v[44:47], v[24:27], v[76:79], v[44:47]
  v_rcp_f32 v101, v131
  s_nop 0
  v_mul_f32 v129, 0xc0135761, v101
  v_mul_f32 v102, v101, v101
  v_mul_f32 v101, 0xbdd2d3e8, v101
  v_mul_f32 v130, v102, v101
  s_cmp_gt_u32 s20, 3
  s_cbranch_scc1 .Lkf_kernel_up4
  v_add_f32 v112, v112, v116
  v_add_f32 v113, v113, v117
  v_add_f32 v114, v114, v118
  v_add_f32 v115, v115, v119
  v_add_f32 v120, v120, v124
  v_add_f32 v121, v121, v125
  v_add_f32 v122, v122, v126
  v_add_f32 v123, v123, v127
  v_add_f32 v112, v112, v120
  v_add_f32 v113, v113, v121
  v_add_f32 v114, v114, v122
  v_add_f32 v115, v115, v123
  s_waitcnt lgkmcnt(1)
  v_fma_f32 v132, v28, v128, v132
  v_fma_f32 v133, v29, v128, v133
  v_fma_f32 v134, v30, v128, v134
  v_fma_f32 v135, v31, v128, v135
  s_waitcnt lgkmcnt(0)
  v_fma_f32 v136, v32, v128, v136
  v_fma_f32 v137, v33, v128, v137
  v_fma_f32 v138, v34, v128, v138
  v_fma_f32 v139, v35, v128, v139
  v_fma_f32 v112, v36, v128, v112
  v_fma_f32 v113, v37, v128, v113
  v_fma_f32 v114, v38, v128, v114
  v_fma_f32 v115, v39, v128, v115
  v_add_f32 v132, v132, v40
  v_add_f32 v133, v133, v41
  v_add_f32 v134, v134, v42
  v_add_f32 v135, v135, v43
  v_add_f32 v136, v136, v44
  v_add_f32 v137, v137, v45
  v_add_f32 v138, v138, v46
  v_add_f32 v139, v139, v47
  v_mul_f32 v64, v112, v112
  v_mul_f32 v65, v113, v113
  v_mul_f32 v66, v114, v114
  v_mul_f32 v67, v115, v115
  v_mul_f32 v68, v132, v132
  v_mul_f32 v69, v133, v133
  v_mul_f32 v70, v134, v134
  v_mul_f32 v71, v135, v135
  v_mul_f32 v72, v136, v136
  v_mul_f32 v73, v137, v137
  v_mul_f32 v74, v138, v138
  v_mul_f32 v75, v139, v139
  v_fma_f32 v64, v64, v130, v129
  v_fma_f32 v65, v65, v130, v129
  v_fma_f32 v66, v66, v130, v129
  v_fma_f32 v67, v67, v130, v129
  v_fma_f32 v68, v68, v130, v129
  v_fma_f32 v69, v69, v130, v129
  v_fma_f32 v70, v70, v130, v129
  v_fma_f32 v71, v71, v130, v129
  v_fma_f32 v72, v72, v130, v129
  v_fma_f32 v73, v73, v130, v129
  v_fma_f32 v74, v74, v130, v129
  v_fma_f32 v75, v75, v130, v129
  v_mul_f32 v64, v64, v112
  v_mul_f32 v65, v65, v113
  v_mul_f32 v66, v66, v114
  v_mul_f32 v67, v67, v115
  v_mul_f32 v68, v68, v132
  v_mul_f32 v69, v69, v133
  v_mul_f32 v70, v70, v134
  v_mul_f32 v71, v71, v135
  v_mul_f32 v72, v72, v136
  v_mul_f32 v73, v73, v137
  v_mul_f32 v74, v74, v138
  v_mul_f32 v75, v75, v139
  v_exp_f32 v64, v64
  v_exp_f32 v65, v65
  v_exp_f32 v66, v66
  v_exp_f32 v67, v67
  v_exp_f32 v68, v68
  v_exp_f32 v69, v69
  v_exp_f32 v70, v70
  v_exp_f32 v71, v71
  v_exp_f32 v72, v72
  v_exp_f32 v73, v73
  v_exp_f32 v74, v74
  v_exp_f32 v75, v75
  v_fma_f32 v64, v64, v131, v131
  v_fma_f32 v65, v65, v131, v131
  v_fma_f32 v66, v66, v131, v131
  v_fma_f32 v67, v67, v131, v131
  v_fma_f32 v68, v68, v131, v131
  v_fma_f32 v69, v69, v131, v131
  v_fma_f32 v70, v70, v131, v131
  v_fma_f32 v71, v71, v131, v131
  v_fma_f32 v72, v72, v131, v131
  v_fma_f32 v73, v73, v131, v131
  v_fma_f32 v74, v74, v131, v131
  v_fma_f32 v75, v75, v131, v131
  v_rcp_f32 v64, v64
  v_rcp_f32 v65, v65
  v_rcp_f32 v66, v66
  v_rcp_f32 v67, v67
  v_rcp_f32 v68, v68
  v_rcp_f32 v69, v69
  v_rcp_f32 v70, v70
  v_rcp_f32 v71, v71
  v_rcp_f32 v72, v72
  v_rcp_f32 v73, v73
  v_rcp_f32 v74, v74
  v_rcp_f32 v75, v75
  v_mul_f32 v112, v112, v64
  v_mul_f32 v113, v113, v65
  v_mul_f32 v114, v114, v66
  v_mul_f32 v115, v115, v67
  v_mul_f32 v132, v132, v68
  v_mul_f32 v133, v133, v69
  v_mul_f32 v134, v134, v70
  v_mul_f32 v135, v135, v71
  v_mul_f32 v136, v136, v72
  v_mul_f32 v137, v137, v73
  v_mul_f32 v138, v138, v74
  v_mul_f32 v139, v139, v75
  v_cvt_pk_bf16_f32 v84, v112, v113
  v_cvt_pk_bf16_f32 v85, v114, v115
  buffer_store_dwordx2 v[84:85], v144, s[44:47], s41 offen sc1
  v_cvt_pk_bf16_f32 v80, v132, v136
  v_cvt_pk_bf16_f32 v81, v133, v137
  v_cvt_pk_bf16_f32 v82, v134, v138
  v_cvt_pk_bf16_f32 v83, v135, v139
  buffer_store_dwordx4 v[80:83], v155, s[44:47], s40 offen sc1
  s_branch .Lkf_kernel_join3
.Lkf_kernel_up4:
  buffer_store_dwordx2 v[98:99], v146, s[12:15], s53 offen sc1
  v_mov_b32 v112, 0
  v_mov_b32 v113, 0
  v_mov_b32 v114, 0
  v_mov_b32 v115, 0
  s_waitcnt lgkmcnt(1)
  v_fma_f32 v132, v28, v128, v132
  v_fma_f32 v133, v29, v128, v133
  v_fma_f32 v134, v30, v128, v134
  v_fma_f32 v135, v31, v128, v135
  s_waitcnt lgkmcnt(0)
  v_fma_f32 v136, v32, v128, v136
  v_fma_f32 v137, v33, v128, v137
  v_fma_f32 v138, v34, v128, v138
  v_fma_f32 v139, v35, v128, v139
  v_add_f32 v132, v132, v40
  v_add_f32 v133, v133, v41
  v_add_f32 v134, v134, v42
  v_add_f32 v135, v135, v43
  v_add_f32 v136, v136, v44
  v_add_f32 v137, v137, v45
  v_add_f32 v138, v138, v46
  v_add_f32 v139, v139, v47
  v_mul_f32 v64, v132, v132
  v_mul_f32 v65, v133, v133
  v_mul_f32 v66, v134, v134
  v_mul_f32 v67, v135, v135
  v_mul_f32 v68, v136, v136
  v_mul_f32 v69, v137, v137
  v_mul_f32 v70, v138, v138
  v_mul_f32 v71, v139, v139
  v_fma_f32 v64, v64, v130, v129
  v_fma_f32 v65, v65, v130, v129
  v_fma_f32 v66, v66, v130, v129
  v_fma_f32 v67, v67, v130, v129
  v_fma_f32 v68, v68, v130, v129
  v_fma_f32 v69, v69, v130, v129
  v_fma_f32 v70, v70, v130, v129
  v_fma_f32 v71, v71, v130, v129
  v_mul_f32 v64, v64, v132
  v_mul_f32 v65, v65, v133
  v_mul_f32 v66, v66, v134
  v_mul_f32 v67, v67, v135
  v_mul_f32 v68, v68, v136
  v_mul_f32 v69, v69, v137
  v_mul_f32 v70, v70, v138
  v_mul_f32 v71, v71, v139
  v_exp_f32 v64, v64
  v_exp_f32 v65, v65
  v_exp_f32 v66, v66
  v_exp_f32 v67, v67
  v_exp_f32 v68, v68
  v_exp_f32 v69, v69
  v_exp_f32 v70, v70
  v_exp_f32 v71, v71
  v_fma_f32 v64, v64, v131, v131
  v_fma_f32 v65, v65, v131, v131
  v_fma_f32 v66, v66, v131, v131
  v_fma_f32 v67, v67, v131, v131
  v_fma_f32 v68, v68, v131, v131
  v_fma_f32 v69, v69, v131, v131
  v_fma_f32 v70, v70, v131, v131
  v_fma_f32 v71, v71, v131, v131
  v_rcp_f32 v64, v64
  v_rcp_f32 v65, v65
  v_rcp_f32 v66, v66
  v_rcp_f32 v67, v67
  v_rcp_f32 v68, v68
  v_rcp_f32 v69, v69
  v_rcp_f32 v70, v70
  v_rcp_f32 v71, v71
  v_mul_f32 v132, v132, v64
  v_mul_f32 v133, v133, v65
  v_mul_f32 v134, v134, v66
  v_mul_f32 v135, v135, v67
  v_mul_f32 v136, v136, v68
  v_mul_f32 v137, v137, v69
  v_mul_f32 v138, v138, v70
  v_mul_f32 v139, v139, v71
  v_cvt_pk_bf16_f32 v80, v132, v136
  v_cvt_pk_bf16_f32 v81, v133, v137
  v_cvt_pk_bf16_f32 v82, v134, v138
  v_cvt_pk_bf16_f32 v83, v135, v139
  buffer_store_dwordx4 v[80:83], v155, s[44:47], s40 offen sc1
  s_and_b32 s42, s22, 1
  s_mul_i32 s43, s42, 63
  s_lshl_b32 s48, s29, 8
  s_add_u32 s48, s48, s21
  s_cmp_lg_u32 s48, s43
  s_cbranch_scc1 .Lkf_kernel_fin5
  s_lshr_b32 s43, s22, 1
  s_add_u32 s48, s43, 1
  s_sub_u32 s43, 2049, s43
  s_cmp_eq_u32 s42, 0
  s_cselect_b32 s43, s48, s43
  s_add_u32 s43, s43, s39
  s_lshl_b32 s43, s43, 6
  v_lshrrev_b32 v5, 7, v3
  v_mul_u32_u24 v5, 131328, v5
  v_and_b32 v155, 0x70, v3
  v_add_u32 v5, v155, v5
  v_mov_b32 v155, 0x40000000
  v_cmp_gt_u32 vcc, 640, v3
  s_nop 1
  v_cndmask_b32 v5, v155, v5, vcc
  buffer_store_dwordx4 v[112:115], v5, s[44:47], s43 offen sc1
.Lkf_kernel_fin5:
.Lkf_kernel_join3:
  s_waitcnt vmcnt(0) lgkmcnt(0)
  s_barrier
  s_cmp_lg_u32 s20, 0
  s_cbranch_scc1 .Lkf_kernel_np6
  v_mov_b32 v5, 1
  buffer_atomic_add v5, v7, s[56:59], s61 offen offset:0 sc1
.Lkf_kernel_np6:
  s_nop 1
  s_add_u32 m0, s26, 16384
  s_add_u32 s62, s63, 16384
  buffer_load_dwordx4 v3, s[4:7], s62 offen lds
  s_add_u32 m0, s26, 24576
  s_add_u32 s62, s63, 24576
  buffer_load_dwordx4 v3, s[4:7], s62 offen lds
  s_add_u32 m0, s26, 32768
  s_add_u32 s62, s63, 32768
  buffer_load_dwordx4 v3, s[4:7], s62 offen lds
  s_add_u32 m0, s26, 40960
  s_add_u32 s62, s63, 40960
  buffer_load_dwordx4 v3, s[4:7], s62 offen lds
  s_add_u32 m0, s26, 90112
  s_add_u32 s62, s63, 90112
  buffer_load_dwordx4 v3, s[4:7], s62 offen lds
  s_add_u32 m0, s26, 98304
  s_add_u32 s62, s63, 98304
  buffer_load_dwordx4 v3, s[4:7], s62 offen lds
  s_load_dwordx2 s[40:41], s[0:1], 64
  v_lshlrev_b32 v4, 4, v2
  v_lshl_add_u32 v4, v1, 6, v4
  s_bfe_u32 s42, s2, 0x20001
  s_lshl_b32 s42, s42, 2
  s_bfe_u32 s23, s2, 0x20003
  s_add_u32 s42, s42, s23
  s_and_b32 s43, s2, 1
  s_lshl_b32 s43, s43, 3
  s_lshr_b32 s23, s2, 5
  s_add_u32 s43, s43, s23
  s_and_b32 s23, s43, 1
  s_lshl_b32 s21, s42, 1
  s_add_u32 s21, s21, s23
  s_lshr_b32 s22, s43, 1
  s_and_b32 s18, s20, 3
  s_lshr_b32 s19, s20, 2
  s_lshl_b32 s23, s21, 2
  s_add_u32 s23, s23, s18
  s_lshl_b32 s23, s23, 10
  s_lshl_b32 s26, s20, 10
  s_mul_i32 s24, s19, 131328
  s_add_u32 s24, s24, s23
  s_add_u32 s24, s24, 128
  s_add_u32 s8, s16, 0xa16000
  s_addc_u32 s9, s17, 0
  s_mov_b32 s10, 0x281400
  s_mov_b32 s11, 0x00020000
  s_add_u32 s48, s16, 0x17a8000
  s_addc_u32 s49, s17, 0
  s_mov_b32 s50, 0x230000
  s_mov_b32 s51, 0x00020000
  s_mul_i32 s52, s43, 143360
  s_add_u32 s52, s52, s26
  s_mul_i32 s54, s22, 286720
  s_add_u32 s54, s54, s26
  s_lshl_b32 s60, s42, 8
  s_add_u32 s60, s60, 8192
  s_lshr_b32 s27, s22, 1
  s_mul_i32 s27, s27, 5
  s_add_u32 s28, s27, 2
  s_and_b32 s29, s22, 1
  s_mul_i32 s30, s29, 3
  s_add_u32 s27, s27, s30
  s_lshl_b32 s29, s29, 5
  v_lshrrev_b32 v5, 1, v2
  v_lshlrev_b32 v6, 4, v1
  v_lshl_add_u32 v6, v5, 8, v6
  v_and_b32 v5, 1, v2
  v_lshl_add_u32 v6, v5, 3, v6
  s_add_u32 s27, s27, s19
  s_lshl_b32 s32, s27, 17
  s_add_u32 s32, s32, s23
  s_lshl_b32 s35, s28, 17
  s_add_u32 s35, s35, s23
  s_lshl_b32 s33, s19, 30
  s_add_u32 s35, s35, s33
  s_lshl_b32 s34, s29, 4
  s_add_u32 s34, s34, s35
  s_mov_b32 s36, 0xffff0000
  s_add_u32 s12, s16, 0x792000
  s_addc_u32 s13, s17, 0
  s_mov_b32 s14, 0x280000
  s_mov_b32 s15, 0x00020000
  s_add_u32 s44, s16, 0xa12000
  s_addc_u32 s45, s17, 0
  s_mov_b32 s46, 0x4000
  s_mov_b32 s47, 0x00020000
  s_mul_i32 s37, s19, 7168
  s_mul_i32 s38, s19, 3072
  s_add_u32 s38, s38, 2048
  s_mul_i32 s39, s19, 5120
  s_add_u32 s39, s39, 4096
  v_add_u32 v80, s37, v3
  v_add_u32 v83, 0xf000, v80
  v_add_u32 v81, s38, v3
  v_add_u32 v84, 0xf000, v81
  v_add_u32 v82, s39, v3
  v_add_u32 v85, 0xf000, v82
  s_cmp_lg_u32 s20, 0
  s_cbranch_scc1 .Lkf_kernel_done8
  s_lshl_b32 s61, s21, 1
  v_and_b32 v96, 3, v0
  v_add_u32 v96, s61, v96
  v_med3_u32 v96, v96, 1, 64
  v_add_u32 v96, -1, v96
  v_lshlrev_b32 v96, 7, v96
  s_mov_b32 s62, 0x4000
.Lkf_kernel_spin7:
  buffer_load_dword v5, v96, s[56:59], 0 offen sc1
  s_waitcnt vmcnt(0)
  v_cmp_gt_u32 vcc, 4, v5
  s_sub_u32 s62, s62, 1
  s_cbranch_scc1 .Lkf_kernel_done8
  s_cbranch_vccnz .Lkf_kernel_spin7
.Lkf_kernel_done8:
  s_waitcnt vmcnt(0)
  s_barrier
  buffer_load_dwordx4 a[0:3], v4, s[8:11], s24 offen sc1
  s_add_u32 s24, s24, 262656
  buffer_load_dwordx4 a[4:7], v4, s[8:11], s24 offen sc1
  s_add_u32 s24, s24, 262656
  buffer_load_dwordx4 a[8:11], v4, s[8:11], s24 offen sc1
  s_add_u32 s24, s24, 262656
  buffer_load_dwordx4 a[12:15], v4, s[8:11], s24 offen sc1
  s_add_u32 s24, s24, 262656
  buffer_load_dwordx4 a[16:19], v4, s[8:11], s24 offen sc1
  s_add_u32 s24, s24, 262656
  ds_read_b128 v[48:51], v81 offset:0
  ds_read_b128 v[52:55], v81 offset:1024
  buffer_load_dwordx4 a[20:23], v4, s[8:11], s24 offen sc1
  s_add_u32 s24, s24, 262656
  ds_read_b128 v[56:59], v82 offset:0
  ds_read_b128 v[40:43], v80 offset:0
  buffer_load_dwordx4 a[24:27], v4, s[8:11], s24 offen sc1
  s_add_u32 s24, s24, 262656
  ds_read_b128 v[44:47], v80 offset:1024
  buffer_load_dwordx4 a[28:31], v4, s[8:11], s24 offen sc1
  s_add_u32 s24, s24, 262656
  buffer_load_dwordx4 a[32:35], v4, s[8:11], s24 offen sc1
  s_add_u32 s24, s24, 262656
  buffer_load_dwordx4 a[36:39], v4, s[8:11], s24 offen sc1
  buffer_load_dwordx4 v[88:91], v3, s[12:15], s32 offen sc1
  buffer_load_dwordx2 v[92:93], v6, s[12:15], s34 offen sc1
  s_lshr_b32 s31, s23, 3
  v_lshlrev_b32 v5, 3, v1
  buffer_load_dwordx2 v[96:97], v5, s[44:47], s31 offen sc1
  s_waitcnt vmcnt(12) lgkmcnt(0)
  v_mfma_f32_16x16x32_bf16 v[28:31], v[48:51], a[0:3], 0
  ds_read_b128 v[68:71], v81 offset:10240
  v_mfma_f32_16x16x32_bf16 v[32:35], v[52:55], a[0:3], 0
  ds_read_b128 v[72:75], v81 offset:11264
  v_mfma_f32_16x16x32_bf16 v[36:39], v[56:59], a[0:3], 0
  ds_read_b128 v[76:79], v82 offset:10240
  v_mfma_f32_16x16x32_bf16 v[20:23], v[40:43], a[0:3], 0
  ds_read_b128 v[60:63], v80 offset:10240
  v_mfma_f32_16x16x32_bf16 v[24:27], v[44:47], a[0:3], 0
  ds_read_b128 v[64:67], v80 offset:11264
  s_waitcnt vmcnt(11) lgkmcnt(4)
  v_mfma_f32_16x16x32_bf16 v[28:31], v[68:71], a[4:7], v[28:31]
  ds_read_b128 v[48:51], v81 offset:20480
  s_waitcnt lgkmcnt(4)
  v_mfma_f32_16x16x32_bf16 v[32:35], v[72:75], a[4:7], v[32:35]
  ds_read_b128 v[52:55], v81 offset:21504
  s_waitcnt lgkmcnt(4)
  v_mfma_f32_16x16x32_bf16 v[36:39], v[76:79], a[4:7], v[36:39]
  s_add_u32 m0, s26, 106496
  s_add_u32 s53, s52, 0
  buffer_load_dwordx4 v3, s[48:51], s53 offen lds
  ds_read_b128 v[56:59], v82 offset:20480
  s_waitcnt lgkmcnt(4)
  v_mfma_f32_16x16x32_bf16 v[20:23], v[60:63], a[4:7], v[20:23]
  ds_read_b128 v[40:43], v80 offset:20480
  s_waitcnt lgkmcnt(4)
  v_mfma_f32_16x16x32_bf16 v[24:27], v[64:67], a[4:7], v[24:27]
  s_add_u32 m0, s26, 114688
  s_add_u32 s53, s52, 8192
  buffer_load_dwordx4 v3, s[48:51], s53 offen lds
  ds_read_b128 v[44:47], v80 offset:21504
  s_add_u32 m0, s26, 122880
  s_add_u32 s53, s52, 16384
  buffer_load_dwordx4 v3, s[48:51], s53 offen lds
  s_waitcnt vmcnt(13) lgkmcnt(4)
  v_mfma_f32_16x16x32_bf16 v[28:31], v[48:51], a[8:11], v[28:31]
  ds_read_b128 v[68:71], v81 offset:30720
  s_waitcnt lgkmcnt(4)
  v_mfma_f32_16x16x32_bf16 v[32:35], v[52:55], a[8:11], v[32:35]
  ds_read_b128 v[72:75], v81 offset:31744
  s_waitcnt lgkmcnt(4)
  v_mfma_f32_16x16x32_bf16 v[36:39], v[56:59], a[8:11], v[36:39]
  s_add_u32 m0, s26, 131072
  s_add_u32 s53, s52, 24576
  buffer_load_dwordx4 v3, s[48:51], s53 offen lds
  ds_read_b128 v[76:79], v82 offset:30720
  s_waitcnt lgkmcnt(4)
  v_mfma_f32_16x16x32_bf16 v[20:23], v[40:43], a[8:11], v[20:23]
  ds_read_b128 v[60:63], v80 offset:30720
  s_waitcnt lgkmcnt(4)
  v_mfma_f32_16x16x32_bf16 v[24:27], v[44:47], a[8:11], v[24:27]
  s_add_u32 m0, s26, 139264
  s_add_u32 s53, s52, 32768
  buffer_load_dwordx4 v3, s[48:51], s53 offen lds
  ds_read_b128 v[64:67], v80 offset:31744
  s_add_u32 m0, s26, 147456
  s_add_u32 s53, s52, 40960
  buffer_load_dwordx4 v3, s[48:51], s53 offen lds
  s_waitcnt vmcnt(15) lgkmcnt(4)
  v_mfma_f32_16x16x32_bf16 v[28:31], v[68:71], a[12:15], v[28:31]
  ds_read_b128 v[48:51], v81 offset:40960
  s_waitcnt lgkmcnt(4)
  v_mfma_f32_16x16x32_bf16 v[32:35], v[72:75], a[12:15], v[32:35]
  ds_read_b128 v[52:55], v81 offset:41984
  s_waitcnt lgkmcnt(4)
  v_mfma_f32_16x16x32_bf16 v[36:39], v[76:79], a[12:15], v[36:39]
  s_add_u32 m0, s26, 155648
  s_add_u32 s53, s52, 49152
  buffer_load_dwordx4 v3, s[48:51], s53 offen lds
  s_waitcnt lgkmcnt(3)
  v_mfma_f32_16x16x32_bf16 v[20:23], v[60:63], a[12:15], v[20:23]
  ds_read_b128 v[56:59], v82 offset:40960
  s_waitcnt lgkmcnt(3)
  v_mfma_f32_16x16x32_bf16 v[24:27], v[64:67], a[12:15], v[24:27]
  ds_read_b128 v[40:43], v80 offset:40960
  ds_read_b128 v[44:47], v80 offset:41984
  s_waitcnt vmcnt(15) lgkmcnt(4)
  v_mfma_f32_16x16x32_bf16 v[28:31], v[48:51], a[16:19], v[28:31]
  ds_read_b128 v[68:71], v81 offset:51200
  s_waitcnt lgkmcnt(4)
  v_mfma_f32_16x16x32_bf16 v[32:35], v[52:55], a[16:19], v[32:35]
  ds_read_b128 v[72:75], v81 offset:52224
  s_waitcnt lgkmcnt(4)
  v_mfma_f32_16x16x32_bf16 v[36:39], v[56:59], a[16:19], v[36:39]
  ds_read_b128 v[76:79], v82 offset:51200
  s_waitcnt lgkmcnt(4)
  v_mfma_f32_16x16x32_bf16 v[20:23], v[40:43], a[16:19], v[20:23]
  ds_read_b128 v[60:63], v80 offset:51200
  s_waitcnt lgkmcnt(4)
  v_mfma_f32_16x16x32_bf16 v[24:27], v[44:47], a[16:19], v[24:27]
  ds_read_b128 v[64:67], v80 offset:52224
  s_barrier
  s_waitcnt vmcnt(14) lgkmcnt(4)
  v_mfma_f32_16x16x32_bf16 v[28:31], v[68:71], a[20:23], v[28:31]
  ds_read_b128 v[48:51], v84 offset:0
  s_waitcnt lgkmcnt(4)
  v_mfma_f32_16x16x32_bf16 v[32:35], v[72:75], a[20:23], v[32:35]
  ds_read_b128 v[52:55], v84 offset:1024
  s_waitcnt lgkmcnt(4)
  v_mfma_f32_16x16x32_bf16 v[36:39], v[76:79], a[20:23], v[36:39]
  s_add_u32 m0, s26, 0
  s_add_u32 s53, s52, 65536
  buffer_load_dwordx4 v3, s[48:51], s53 offen lds
  s_waitcnt lgkmcnt(3)
  v_mfma_f32_16x16x32_bf16 v[20:23], v[60:63], a[20:23], v[20:23]
  ds_read_b128 v[56:59], v85 offset:0
  s_waitcnt lgkmcnt(3)
  v_mfma_f32_16x16x32_bf16 v[24:27], v[64:67], a[20:23], v[24:27]
  ds_read_b128 v[40:43], v83 offset:0
  ds_read_b128 v[44:47], v83 offset:1024
  s_waitcnt vmcnt(14) lgkmcnt(4)
  v_mfma_f32_16x16x32_bf16 v[28:31], v[48:51], a[24:27], v[28:31]
  ds_read_b128 v[68:71], v84 offset:10240
  s_waitcnt lgkmcnt(4)
  v_mfma_f32_16x16x32_bf16 v[32:35], v[52:55], a[24:27], v[32:35]
  ds_read_b128 v[72:75], v84 offset:11264
  s_waitcnt lgkmcnt(4)
  v_mfma_f32_16x16x32_bf16 v[36:39], v[56:59], a[24:27], v[36:39]
  s_add_u32 m0, s26, 8192
  s_add_u32 s53, s52, 73728
  buffer_load_dwordx4 v3, s[48:51], s53 offen lds
  s_waitcnt lgkmcnt(3)
  v_mfma_f32_16x16x32_bf16 v[20:23], v[40:43], a[24:27], v[20:23]
  ds_read_b128 v[76:79], v85 offset:10240
  s_waitcnt lgkmcnt(3)
  v_mfma_f32_16x16x32_bf16 v[24:27], v[44:47], a[24:27], v[24:27]
  ds_read_b128 v[60:63], v83 offset:10240
  ds_read_b128 v[64:67], v83 offset:11264
  s_barrier
  s_waitcnt vmcnt(14) lgkmcnt(4)
  v_mfma_f32_16x16x32_bf16 v[28:31], v[68:71], a[28:31], v[28:31]
  ds_read_b128 v[48:51], v84 offset:20480
  s_waitcnt lgkmcnt(4)
  v_mfma_f32_16x16x32_bf16 v[32:35], v[72:75], a[28:31], v[32:35]
  ds_read_b128 v[52:55], v84 offset:21504
  s_waitcnt lgkmcnt(4)
  v_mfma_f32_16x16x32_bf16 v[36:39], v[76:79], a[28:31], v[36:39]
  s_add_u32 m0, s26, 16384
  s_add_u32 s53, s52, 81920
  buffer_load_dwordx4 v3, s[48:51], s53 offen lds
  s_waitcnt lgkmcnt(3)
  v_mfma_f32_16x16x32_bf16 v[20:23], v[60:63], a[28:31], v[20:23]
  ds_read_b128 v[56:59], v85 offset:20480
  s_waitcnt lgkmcnt(3)
  v_mfma_f32_16x16x32_bf16 v[24:27], v[64:67], a[28:31], v[24:27]
  ds_read_b128 v[40:43], v83 offset:20480
  ds_read_b128 v[44:47], v83 offset:21504
  s_waitcnt vmcnt(14) lgkmcnt(4)
  v_mfma_f32_16x16x32_bf16 v[28:31], v[48:51], a[32:35], v[28:31]
  ds_read_b128 v[68:71], v84 offset:30720
  s_waitcnt lgkmcnt(4)
  v_mfma_f32_16x16x32_bf16 v[32:35], v[52:55], a[32:35], v[32:35]
  ds_read_b128 v[72:75], v84 offset:31744
  s_waitcnt lgkmcnt(4)
  v_mfma_f32_16x16x32_bf16 v[36:39], v[56:59], a[32:35], v[36:39]
  s_add_u32 m0, s26, 24576
  s_add_u32 s53, s52, 90112
  buffer_load_dwordx4 v3, s[48:51], s53 offen lds
  s_waitcnt lgkmcnt(3)
  v_mfma_f32_16x16x32_bf16 v[20:23], v[40:43], a[32:35], v[20:23]
  ds_read_b128 v[76:79], v85 offset:30720
  s_waitcnt lgkmcnt(3)
  v_mfma_f32_16x16x32_bf16 v[24:27], v[44:47], a[32:35], v[24:27]
  ds_read_b128 v[60:63], v83 offset:30720
  ds_read_b128 v[64:67], v83 offset:31744
  s_waitcnt vmcnt(14) lgkmcnt(4)
  v_mfma_f32_16x16x32_bf16 v[28:31], v[68:71], a[36:39], v[28:31]
  s_waitcnt lgkmcnt(3)
  v_mfma_f32_16x16x32_bf16 v[32:35], v[72:75], a[36:39], v[32:35]
  s_waitcnt lgkmcnt(2)
  v_mfma_f32_16x16x32_bf16 v[36:39], v[76:79], a[36:39], v[36:39]
  s_waitcnt lgkmcnt(1)
  v_mfma_f32_16x16x32_bf16 v[20:23], v[60:63], a[36:39], v[20:23]
  s_waitcnt lgkmcnt(0)
  v_mfma_f32_16x16x32_bf16 v[24:27], v[64:67], a[36:39], v[24:27]
  s_mul_i32 s37, s20, 3072
  s_xor_b32 s38, s20, 4
  s_mul_i32 s38, s38, 3072
  s_add_u32 s37, s37, 40960
  s_add_u32 s38, s38, 40960
  v_add_u32 v80, s37, v3
  v_add_u32 v81, s38, v3
  ds_write_b128 v80, v[28:31] offset:0
  ds_write_b128 v80, v[32:35] offset:1024
  ds_write_b128 v80, v[36:39] offset:2048
  s_waitcnt vmcnt(13)
  v_lshlrev_b32 v8, 16, v88
  s_waitcnt vmcnt(11)
  v_fma_f32 v40, v8, v96, v97
  v_and_b32 v9, s36, v88
  v_fma_f32 v41, v9, v96, v97
  v_lshlrev_b32 v10, 16, v89
  v_fma_f32 v42, v10, v96, v97
  v_and_b32 v11, s36, v89
  v_fma_f32 v43, v11, v96, v97
  v_lshlrev_b32 v12, 16, v90
  v_fma_f32 v44, v12, v96, v97
  v_and_b32 v13, s36, v90
  v_fma_f32 v45, v13, v96, v97
  v_lshlrev_b32 v14, 16, v91
  v_fma_f32 v46, v14, v96, v97
  v_and_b32 v15, s36, v91
  v_fma_f32 v47, v15, v96, v97
  v_lshlrev_b32 v16, 16, v92
  v_fma_f32 v48, v16, v96, v97
  v_and_b32 v17, s36, v92
  v_fma_f32 v49, v17, v96, v97
  v_lshlrev_b32 v18, 16, v93
  v_fma_f32 v50, v18, v96, v97
  v_and_b32 v19, s36, v93
  v_fma_f32 v51, v19, v96, v97
  v_add_f32 v20, v20, v40
  v_add_f32 v24, v24, v41
  v_add_f32 v21, v21, v42
  v_add_f32 v25, v25, v43
  v_add_f32 v22, v22, v44
  v_add_f32 v26, v26, v45
  v_add_f32 v23, v23, v46
  v_add_f32 v27, v27, v47
  v_add_f32 v36, v36, v48
  v_add_f32 v37, v37, v49
  v_add_f32 v38, v38, v50
  v_add_f32 v39, v39, v51
  s_add_u32 s12, s16, 0xc98000
  s_addc_u32 s13, s17, 0
  s_mov_b32 s14, 0x280000
  s_mov_b32 s15, 0x00020000
  s_add_u32 s8, s16, 0xf18000
  s_addc_u32 s9, s17, 0
  s_mov_b32 s10, 0x40000
  s_mov_b32 s11, 0x00020000
  s_lshl_b32 s37, s22, 1
  s_add_u32 s37, s37, s19
  s_lshl_b32 s37, s37, 7
  s_lshl_b32 s38, s23, 1
  s_add_u32 s37, s37, s38
  s_mov_b32 s38, 0x3f803f80
  s_sub_u32 s39, s19, 1
  v_lshlrev_b32 v82, 28, v2
  v_lshl_add_u32 v82, v1, 3, v82
  s_waitcnt lgkmcnt(0)
  s_barrier
  ds_read_b128 v[60:63], v81 offset:0
  ds_read_b128 v[64:67], v81 offset:1024
  ds_read_b128 v[68:71], v81 offset:2048
  s_waitcnt lgkmcnt(2)
  v_add_f32 v20, v20, v60
  v_add_f32 v21, v21, v61
  v_add_f32 v22, v22, v62
  v_add_f32 v23, v23, v63
  s_waitcnt lgkmcnt(1)
  v_add_f32 v24, v24, v64
  v_add_f32 v25, v25, v65
  v_add_f32 v26, v26, v66
  v_add_f32 v27, v27, v67
  v_cvt_pk_bf16_f32 v88, v20, v24
  v_cvt_pk_bf16_f32 v89, v21, v25
  v_cvt_pk_bf16_f32 v90, v22, v26
  v_cvt_pk_bf16_f32 v91, v23, v27
  buffer_store_dwordx4 v[88:91], v3, s[12:15], s32 offen sc1
  s_waitcnt lgkmcnt(0)
  v_add_f32 v36, v36, v68
  v_add_f32 v37, v37, v69
  v_add_f32 v38, v38, v70
  v_add_f32 v39, v39, v71
  v_cvt_pk_bf16_f32 v92, v36, v37
  v_cvt_pk_bf16_f32 v93, v38, v39
  buffer_store_dwordx2 v[92:93], v6, s[12:15], s34 offen sc1
  v_and_b32 v100, s39, v92
  v_and_b32 v101, s39, v93
  v_dot2_f32_bf16 v96, v88, s38, 0
  v_dot2_f32_bf16 v97, v88, v88, 0
  v_dot2_f32_bf16 v96, v89, s38, v96
  v_dot2_f32_bf16 v97, v89, v89, v97
  v_dot2_f32_bf16 v96, v90, s38, v96
  v_dot2_f32_bf16 v97, v90, v90, v97
  v_dot2_f32_bf16 v96, v91, s38, v96
  v_dot2_f32_bf16 v97, v91, v91, v97
  v_dot2_f32_bf16 v96, v100, s38, v96
  v_dot2_f32_bf16 v97, v100, v100, v97
  v_dot2_f32_bf16 v96, v101, s38, v96
  v_dot2_f32_bf16 v97, v101, v101, v97
  s_nop 1
  v_mov_b32 v98, v96
  s_nop 1
  v_permlane32_swap_b32 v96, v98
  v_add_f32 v96, v96, v98
  v_mov_b32 v98, v96
  s_nop 1
  v_permlane16_swap_b32 v96, v98
  v_add_f32 v96, v96, v98
  v_mov_b32 v99, v97
  s_nop 1
  v_permlane32_swap_b32 v97, v99
  v_add_f32 v97, v97, v99
  v_mov_b32 v99, v97
  s_nop 1
  v_permlane16_swap_b32 v97, v99
  v_add_f32 v97, v97, v99
  buffer_store_dwordx2 v[96:97], v82, s[8:11], s37 offen sc1
  v_lshlrev_b32 v60, 16, v88
  v_add_f32 v8, v8, v60
  v_and_b32 v61, s36, v88
  v_add_f32 v9, v9, v61
  v_lshlrev_b32 v62, 16, v89
  v_add_f32 v10, v10, v62
  v_and_b32 v63, s36, v89
  v_add_f32 v11, v11, v63
  v_lshlrev_b32 v64, 16, v90
  v_add_f32 v12, v12, v64
  v_and_b32 v65, s36, v90
  v_add_f32 v13, v13, v65
  v_lshlrev_b32 v66, 16, v91
  v_add_f32 v14, v14, v66
  v_and_b32 v67, s36, v91
  v_add_f32 v15, v15, v67
  v_lshlrev_b32 v68, 16, v92
  v_add_f32 v16, v16, v68
  v_and_b32 v69, s36, v92
  v_add_f32 v17, v17, v69
  v_lshlrev_b32 v70, 16, v93
  v_add_f32 v18, v18, v70
  v_and_b32 v71, s36, v93
  v_add_f32 v19, v19, v71
  s_add_u32 s4, s16, 0x19d8000
  s_addc_u32 s5, s17, 0
  s_mov_b32 s6, 0x230000
  s_mov_b32 s7, 0x00020000
  s_add_u32 s44, s16, 0x1c08000
  s_addc_u32 s45, s17, 0
  s_mov_b32 s46, 0x1c00
  s_mov_b32 s47, 0x00020000
  s_mul_i32 s37, s43, 448
  s_lshl_b32 s24, s42, 13
  s_add_u32 s24, s24, s26
  s_lshl_b32 s38, s24, 1
  s_waitcnt vmcnt(0)
  s_barrier
  s_cmp_lg_u32 s20, 0
  s_cbranch_scc1 .Lkf_kernel_np11
  v_mov_b32 v5, 1
  buffer_atomic_add v5, v7, s[56:59], s60 offen offset:0 sc1
.Lkf_kernel_np11:
  s_nop 1
  s_add_u32 m0, s26, 98304
  s_add_u32 s53, s52, 57344
  buffer_load_dwordx4 v3, s[48:51], s53 offen lds
  s_add_u32 m0, s26, 32768
  s_add_u32 s53, s52, 98304
  buffer_load_dwordx4 v3, s[48:51], s53 offen lds
  s_add_u32 m0, s26, 40960
  s_add_u32 s53, s52, 106496
  buffer_load_dwordx4 v3, s[48:51], s53 offen lds
  s_add_u32 m0, s26, 49152
  s_add_u32 s53, s52, 114688
  buffer_load_dwordx4 v3, s[48:51], s53 offen lds
  s_add_u32 m0, s26, 57344
  s_add_u32 s53, s52, 122880
  buffer_load_dwordx4 v3, s[48:51], s53 offen lds
  s_add_u32 m0, s26, 65536
  s_add_u32 s53, s52, 131072
  buffer_load_dwordx4 v3, s[48:51], s53 offen lds
  s_add_u32 m0, s26, 73728
  s_add_u32 s53, s52, 139264
  buffer_load_dwordx4 v3, s[48:51], s53 offen lds
  v_lshlrev_b32 v4, 4, v2
  buffer_load_dwordx4 v[48:51], v4, s[44:47], s37 offen offset:0
  buffer_load_dwordx4 v[52:55], v4, s[44:47], s37 offen offset:64
  buffer_load_dwordx4 v[56:59], v4, s[44:47], s37 offen offset:128
  buffer_load_dwordx4 v[60:63], v4, s[44:47], s37 offen offset:192
  buffer_load_dwordx4 v[64:67], v4, s[44:47], s37 offen offset:256
  buffer_load_dwordx4 v[68:71], v4, s[44:47], s37 offen offset:320
  buffer_load_dwordx4 v[72:75], v4, s[44:47], s37 offen offset:384
  s_add_u32 m0, s26, 81920
  s_add_u32 s53, s54, 0
  buffer_load_dwordx4 v3, s[4:7], s53 offen lds
  s_add_u32 m0, s26, 90112
  s_add_u32 s53, s54, 8192
  buffer_load_dwordx4 v3, s[4:7], s53 offen lds
  v_lshlrev_b32 v4, 9, v2
  v_lshl_add_u32 v4, v1, 3, v4
  v_add_u32 v116, 0x10000, v3
  v_add_u32 v117, 0x20000, v3
  s_cmp_lg_u32 s20, 0
  s_cbranch_scc1 .Lkf_kernel_done10
  s_mov_b32 s62, 0x4000
.Lkf_kernel_spin9:
  buffer_load_dword v5, v7, s[56:59], s60 offen offset:0 sc1
  s_waitcnt vmcnt(0)
  v_readfirstlane_b32 s61, v5
  s_sub_u32 s62, s62, 1
  s_cselect_b32 s61, 16, s61
  s_cmp_lt_u32 s61, 16
  s_cbranch_scc1 .Lkf_kernel_spin9
.Lkf_kernel_done10:
  s_barrier
  s_mov_b32 s25, s24
  buffer_load_dwordx4 a[0:3], v3, s[12:15], s25 offen sc1
  s_add_u32 s25, s25, 131072
  ds_read_b128 v[84:87], v116 offset:40960
  buffer_load_dwordx4 a[4:7], v3, s[12:15], s25 offen sc1
  s_add_u32 s25, s25, 131072
  ds_read_b128 v[88:91], v116 offset:41984
  buffer_load_dwordx4 a[8:11], v3, s[12:15], s25 offen sc1
  s_add_u32 s25, s25, 131072
  ds_read_b128 v[92:95], v116 offset:43008
  buffer_load_dwordx4 a[12:15], v3, s[12:15], s25 offen sc1
  s_add_u32 s25, s25, 131072
  ds_read_b128 v[96:99], v116 offset:44032
  buffer_load_dwordx4 a[16:19], v3, s[12:15], s25 offen sc1
  s_add_u32 s25, s25, 131072
  ds_read_b128 v[100:103], v116 offset:45056
  buffer_load_dwordx4 a[20:23], v3, s[12:15], s25 offen sc1
  s_add_u32 s25, s25, 131072
  ds_read_b128 v[104:107], v116 offset:46080
  ds_read_b128 v[108:111], v116 offset:47104
  s_waitcnt vmcnt(5) lgkmcnt(6)
  v_mfma_f32_16x16x32_bf16 v[20:23], v[84:87], a[0:3], 0
  ds_read_b128 v[112:115], v116 offset:48128
  s_waitcnt lgkmcnt(6)
  v_mfma_f32_16x16x32_bf16 v[24:27], v[88:91], a[0:3], 0
  ds_read_b128 v[84:87], v116 offset:49152
  s_waitcnt lgkmcnt(6)
  v_mfma_f32_16x16x32_bf16 v[28:31], v[92:95], a[0:3], 0
  ds_read_b128 v[88:91], v116 offset:50176
  buffer_load_dwordx4 a[24:27], v3, s[12:15], s25 offen sc1
  s_add_u32 s25, s25, 131072
  s_waitcnt lgkmcnt(6)
  v_mfma_f32_16x16x32_bf16 v[32:35], v[96:99], a[0:3], 0
  ds_read_b128 v[92:95], v116 offset:51200
  s_waitcnt lgkmcnt(6)
  v_mfma_f32_16x16x32_bf16 v[36:39], v[100:103], a[0:3], 0
  ds_read_b128 v[96:99], v116 offset:52224
  buffer_load_dwordx2 v[76:77], v4, s[8:11], s38 offen offset:0 sc1
  s_waitcnt lgkmcnt(6)
  v_mfma_f32_16x16x32_bf16 v[40:43], v[104:107], a[0:3], 0
  ds_read_b128 v[100:103], v116 offset:53248
  s_waitcnt lgkmcnt(6)
  v_mfma_f32_16x16x32_bf16 v[44:47], v[108:111], a[0:3], 0
  ds_read_b128 v[104:107], v116 offset:54272
  buffer_load_dwordx2 v[78:79], v4, s[8:11], s38 offen offset:128 sc1
  s_waitcnt vmcnt(7) lgkmcnt(6)
  v_mfma_f32_16x16x32_bf16 v[20:23], v[112:115], a[4:7], v[20:23]
  ds_read_b128 v[108:111], v116 offset:55296
  s_waitcnt lgkmcnt(6)
  v_mfma_f32_16x16x32_bf16 v[24:27], v[84:87], a[4:7], v[24:27]
  ds_read_b128 v[112:115], v116 offset:56320
  s_waitcnt lgkmcnt(6)
  v_mfma_f32_16x16x32_bf16 v[28:31], v[88:91], a[4:7], v[28:31]
  ds_read_b128 v[84:87], v116 offset:57344
  buffer_load_dwordx4 a[28:31], v3, s[12:15], s25 offen sc1
  s_add_u32 s25, s25, 131072
  s_waitcnt lgkmcnt(6)
  v_mfma_f32_16x16x32_bf16 v[32:35], v[92:95], a[4:7], v[32:35]
  ds_read_b128 v[88:91], v116 offset:58368
  s_waitcnt lgkmcnt(6)
  v_mfma_f32_16x16x32_bf16 v[36:39], v[96:99], a[4:7], v[36:39]
  ds_read_b128 v[92:95], v116 offset:59392
  buffer_load_dwordx2 v[80:81], v4, s[8:11], s38 offen offset:256 sc1
  s_waitcnt lgkmcnt(6)
  v_mfma_f32_16x16x32_bf16 v[40:43], v[100:103], a[4:7], v[40:43]
  ds_read_b128 v[96:99], v116 offset:60416
  s_waitcnt lgkmcnt(6)
  v_mfma_f32_16x16x32_bf16 v[44:47], v[104:107], a[4:7], v[44:47]
  ds_read_b128 v[100:103], v116 offset:61440
  buffer_load_dwordx2 v[82:83], v4, s[8:11], s38 offen offset:384 sc1
  s_waitcnt vmcnt(9) lgkmcnt(6)
  v_mfma_f32_16x16x32_bf16 v[20:23], v[108:111], a[8:11], v[20:23]
  ds_read_b128 v[104:107], v116 offset:62464
  s_waitcnt lgkmcnt(6)
  v_mfma_f32_16x16x32_bf16 v[24:27], v[112:115], a[8:11], v[24:27]
  ds_read_b128 v[108:111], v116 offset:63488
  s_waitcnt lgkmcnt(6)
  v_mfma_f32_16x16x32_bf16 v[28:31], v[84:87], a[8:11], v[28:31]
  ds_read_b128 v[112:115], v116 offset:64512
  s_waitcnt lgkmcnt(6)
  v_mfma_f32_16x16x32_bf16 v[32:35], v[88:91], a[8:11], v[32:35]
  ds_read_b128 v[84:87], v117 offset:0
  s_waitcnt lgkmcnt(6)
  v_mfma_f32_16x16x32_bf16 v[36:39], v[92:95], a[8:11], v[36:39]
  ds_read_b128 v[88:91], v117 offset:1024
  s_waitcnt lgkmcnt(6)
  v_mfma_f32_16x16x32_bf16 v[40:43], v[96:99], a[8:11], v[40:43]
  ds_read_b128 v[92:95], v117 offset:2048
  s_waitcnt lgkmcnt(6)
  v_mfma_f32_16x16x32_bf16 v[44:47], v[100:103], a[8:11], v[44:47]
  ds_read_b128 v[96:99], v117 offset:3072
  buffer_load_dwordx4 a[32:35], v3, s[12:15], s25 offen sc1
  s_add_u32 s25, s25, 131072
  s_waitcnt vmcnt(9) lgkmcnt(6)
  v_mfma_f32_16x16x32_bf16 v[20:23], v[104:107], a[12:15], v[20:23]
  ds_read_b128 v[100:103], v117 offset:4096
  s_waitcnt lgkmcnt(6)
  v_mfma_f32_16x16x32_bf16 v[24:27], v[108:111], a[12:15], v[24:27]
  ds_read_b128 v[104:107], v117 offset:5120
  s_waitcnt lgkmcnt(6)
  v_mfma_f32_16x16x32_bf16 v[28:31], v[112:115], a[12:15], v[28:31]
  ds_read_b128 v[108:111], v117 offset:6144
  s_waitcnt lgkmcnt(6)
  v_mfma_f32_16x16x32_bf16 v[32:35], v[84:87], a[12:15], v[32:35]
  ds_read_b128 v[112:115], v117 offset:7168
  buffer_load_dwordx4 a[36:39], v3, s[12:15], s25 offen sc1
  s_add_u32 s25, s25, 131072
  s_waitcnt lgkmcnt(6)
  v_mfma_f32_16x16x32_bf16 v[36:39], v[88:91], a[12:15], v[36:39]
  ds_read_b128 v[84:87], v117 offset:8192
  s_waitcnt lgkmcnt(6)
  v_mfma_f32_16x16x32_bf16 v[40:43], v[92:95], a[12:15], v[40:43]
  ds_read_b128 v[88:91], v117 offset:9216
  s_waitcnt lgkmcnt(6)
  v_mfma_f32_16x16x32_bf16 v[44:47], v[96:99], a[12:15], v[44:47]
  ds_read_b128 v[92:95], v117 offset:10240
  s_waitcnt vmcnt(9) lgkmcnt(6)
  v_mfma_f32_16x16x32_bf16 v[20:23], v[100:103], a[16:19], v[20:23]
  ds_read_b128 v[96:99], v117 offset:11264
  s_waitcnt lgkmcnt(6)
  v_mfma_f32_16x16x32_bf16 v[24:27], v[104:107], a[16:19], v[24:27]
  ds_read_b128 v[100:103], v117 offset:12288
  s_waitcnt lgkmcnt(6)
  v_mfma_f32_16x16x32_bf16 v[28:31], v[108:111], a[16:19], v[28:31]
  ds_read_b128 v[104:107], v117 offset:13312
  s_waitcnt lgkmcnt(6)
  v_mfma_f32_16x16x32_bf16 v[32:35], v[112:115], a[16:19], v[32:35]
  ds_read_b128 v[108:111], v117 offset:14336
  s_waitcnt lgkmcnt(6)
  v_mfma_f32_16x16x32_bf16 v[36:39], v[84:87], a[16:19], v[36:39]
  ds_read_b128 v[112:115], v117 offset:15360
  s_waitcnt lgkmcnt(6)
  v_mfma_f32_16x16x32_bf16 v[40:43], v[88:91], a[16:19], v[40:43]
  ds_read_b128 v[84:87], v117 offset:16384
  s_waitcnt lgkmcnt(6)
  v_mfma_f32_16x16x32_bf16 v[44:47], v[92:95], a[16:19], v[44:47]
  ds_read_b128 v[88:91], v117 offset:17408
  buffer_load_dwordx4 a[40:43], v3, s[12:15], s25 offen sc1
  s_add_u32 s25, s25, 131072
  s_waitcnt vmcnt(9) lgkmcnt(6)
  v_mfma_f32_16x16x32_bf16 v[20:23], v[96:99], a[20:23], v[20:23]
  ds_read_b128 v[92:95], v117 offset:18432
  buffer_load_dwordx4 a[44:47], v3, s[12:15], s25 offen sc1
  s_add_u32 s25, s25, 131072
  s_waitcnt lgkmcnt(6)
  v_mfma_f32_16x16x32_bf16 v[24:27], v[100:103], a[20:23], v[24:27]
  ds_read_b128 v[96:99], v117 offset:19456
  s_lshr_b32 s44, s43, 1
  s_waitcnt lgkmcnt(6)
  v_mfma_f32_16x16x32_bf16 v[28:31], v[104:107], a[20:23], v[28:31]
  ds_read_b128 v[100:103], v117 offset:20480
  s_mul_i32 s44, s44, 7
  s_waitcnt lgkmcnt(6)
  v_mfma_f32_16x16x32_bf16 v[32:35], v[108:111], a[20:23], v[32:35]
  ds_read_b128 v[104:107], v117 offset:21504
  s_add_u32 s45, s44, 3
  s_and_b32 s46, s43, 1
  s_waitcnt lgkmcnt(6)
  v_mfma_f32_16x16x32_bf16 v[36:39], v[112:115], a[20:23], v[36:39]
  ds_read_b128 v[108:111], v117 offset:22528
  s_mul_i32 s30, s46, 4
  s_waitcnt lgkmcnt(6)
  v_mfma_f32_16x16x32_bf16 v[40:43], v[84:87], a[20:23], v[40:43]
  ds_read_b128 v[112:115], v117 offset:23552
  s_add_u32 s44, s44, s30
  s_waitcnt lgkmcnt(6)
  v_mfma_f32_16x16x32_bf16 v[44:47], v[88:91], a[20:23], v[44:47]
  ds_read_b128 v[84:87], v117 offset:24576
  s_lshl_b32 s46, s46, 5
  s_add_u32 s8, s16, 0xf58000
  s_waitcnt vmcnt(9) lgkmcnt(6)
  v_mfma_f32_16x16x32_bf16 v[20:23], v[92:95], a[24:27], v[20:23]
  ds_read_b128 v[88:91], v117 offset:25600
  buffer_load_dwordx4 a[48:51], v3, s[12:15], s25 offen sc1
  s_add_u32 s25, s25, 131072
  s_waitcnt lgkmcnt(6)
  v_mfma_f32_16x16x32_bf16 v[24:27], v[96:99], a[24:27], v[24:27]
  ds_read_b128 v[92:95], v117 offset:26624
  s_addc_u32 s9, s17, 0
  s_waitcnt lgkmcnt(6)
  v_mfma_f32_16x16x32_bf16 v[28:31], v[100:103], a[24:27], v[28:31]
  ds_read_b128 v[96:99], v117 offset:27648
  s_mov_b32 s10, 0x6c0000
  s_waitcnt lgkmcnt(6)
  v_mfma_f32_16x16x32_bf16 v[32:35], v[104:107], a[24:27], v[32:35]
  ds_read_b128 v[100:103], v117 offset:28672
  s_mov_b32 s11, 0x00020000
  s_waitcnt vmcnt(8)
  v_add_f32 v76, v76, v78
  s_waitcnt lgkmcnt(6)
  v_mfma_f32_16x16x32_bf16 v[36:39], v[108:111], a[24:27], v[36:39]
  ds_read_b128 v[104:107], v117 offset:29696
  s_waitcnt vmcnt(5)
  v_add_f32 v80, v80, v82
  s_waitcnt lgkmcnt(6)
  v_mfma_f32_16x16x32_bf16 v[40:43], v[112:115], a[24:27], v[40:43]
  ds_read_b128 v[108:111], v117 offset:30720
  v_add_f32 v77, v77, v79
  s_waitcnt lgkmcnt(6)
  v_mfma_f32_16x16x32_bf16 v[44:47], v[84:87], a[24:27], v[44:47]
  ds_read_b128 v[112:115], v117 offset:31744
  v_add_f32 v81, v81, v83
  v_add_f32 v76, v76, v80
  s_barrier
  s_waitcnt lgkmcnt(6)
  v_mfma_f32_16x16x32_bf16 v[20:23], v[88:91], a[28:31], v[20:23]
  ds_read_b128 v[84:87], v116 offset:32768
  buffer_load_dwordx4 a[52:55], v3, s[12:15], s25 offen sc1
  s_add_u32 s25, s25, 131072
  s_waitcnt lgkmcnt(6)
  v_mfma_f32_16x16x32_bf16 v[24:27], v[92:95], a[28:31], v[24:27]
  ds_read_b128 v[88:91], v116 offset:33792
  v_add_f32 v77, v77, v81
  v_mov_b32 v78, v76
  s_waitcnt lgkmcnt(6)
  v_mfma_f32_16x16x32_bf16 v[28:31], v[96:99], a[28:31], v[28:31]
  ds_read_b128 v[92:95], v116 offset:34816
  s_waitcnt lgkmcnt(6)
  v_mfma_f32_16x16x32_bf16 v[32:35], v[100:103], a[28:31], v[32:35]
  ds_read_b128 v[96:99], v116 offset:35840
  v_mov_b32 v79, v77
  v_permlane32_swap_b32 v76, v78
  s_waitcnt lgkmcnt(6)
  v_mfma_f32_16x16x32_bf16 v[36:39], v[104:107], a[28:31], v[36:39]
  ds_read_b128 v[100:103], v116 offset:36864
  v_permlane32_swap_b32 v77, v79
  s_waitcnt lgkmcnt(6)
  v_mfma_f32_16x16x32_bf16 v[40:43], v[108:111], a[28:31], v[40:43]
  ds_read_b128 v[104:107], v116 offset:37888
  s_add_u32 m0, s26, 106496
  s_add_u32 s53, s54, 24576
  buffer_load_dwordx4 v3, s[4:7], s53 offen lds
  v_add_f32 v76, v76, v78
  s_waitcnt lgkmcnt(6)
  v_mfma_f32_16x16x32_bf16 v[44:47], v[112:115], a[28:31], v[44:47]
  ds_read_b128 v[108:111], v116 offset:38912
  v_add_f32 v77, v77, v79
  v_mov_b32 v78, v76
  s_waitcnt vmcnt(6) lgkmcnt(6)
  v_mfma_f32_16x16x32_bf16 v[20:23], v[84:87], a[32:35], v[20:23]
  ds_read_b128 v[112:115], v116 offset:39936
  buffer_load_dwordx4 a[56:59], v3, s[12:15], s25 offen sc1
  s_add_u32 s25, s25, 131072
  s_waitcnt lgkmcnt(6)
  v_mfma_f32_16x16x32_bf16 v[24:27], v[88:91], a[32:35], v[24:27]
  ds_read_b128 v[84:87], v3 offset:0
  v_mov_b32 v79, v77
  s_waitcnt lgkmcnt(6)
  v_mfma_f32_16x16x32_bf16 v[28:31], v[92:95], a[32:35], v[28:31]
  ds_read_b128 v[88:91], v3 offset:1024
  v_permlane16_swap_b32 v76, v78
  v_permlane16_swap_b32 v77, v79
  s_waitcnt lgkmcnt(6)
  v_mfma_f32_16x16x32_bf16 v[32:35], v[96:99], a[32:35], v[32:35]
  ds_read_b128 v[92:95], v3 offset:2048
  v_add_f32 v76, v76, v78
  s_waitcnt lgkmcnt(6)
  v_mfma_f32_16x16x32_bf16 v[36:39], v[100:103], a[32:35], v[36:39]
  ds_read_b128 v[96:99], v3 offset:3072
  s_add_u32 m0, s26, 114688
  s_add_u32 s53, s54, 32768
  buffer_load_dwordx4 v3, s[4:7], s53 offen lds
  v_add_f32 v77, v77, v79
  s_waitcnt lgkmcnt(6)
  v_mfma_f32_16x16x32_bf16 v[40:43], v[104:107], a[32:35], v[40:43]
  ds_read_b128 v[100:103], v3 offset:4096
  v_mul_f32 v76, 0xbacccccd, v76
  s_waitcnt lgkmcnt(6)
  v_mfma_f32_16x16x32_bf16 v[44:47], v[108:111], a[32:35], v[44:47]
  ds_read_b128 v[104:107], v3 offset:5120
  v_mul_f32 v77, 0x3acccccd, v77
  v_fma_f32 v77, -v76, v76, v77
  s_waitcnt vmcnt(7) lgkmcnt(6)
  v_mfma_f32_16x16x32_bf16 v[20:23], v[112:115], a[36:39], v[20:23]
  ds_read_b128 v[108:111], v3 offset:6144
  buffer_load_dwordx4 a[60:63], v3, s[12:15], s25 offen sc1
  s_add_u32 s25, s25, 131072
  s_waitcnt lgkmcnt(6)
  v_mfma_f32_16x16x32_bf16 v[24:27], v[84:87], a[36:39], v[24:27]
  ds_read_b128 v[112:115], v3 offset:7168
  v_max_f32 v77, 0, v77
  s_waitcnt lgkmcnt(6)
  v_mfma_f32_16x16x32_bf16 v[28:31], v[88:91], a[36:39], v[28:31]
  ds_read_b128 v[84:87], v3 offset:8192
  v_cvt_pk_bf16_f32 v77, v77, v77
  v_lshlrev_b32 v77, 16, v77
  s_waitcnt lgkmcnt(6)
  v_mfma_f32_16x16x32_bf16 v[32:35], v[92:95], a[36:39], v[32:35]
  ds_read_b128 v[88:91], v3 offset:9216
  v_cvt_pk_bf16_f32 v76, v76, v76
  s_waitcnt lgkmcnt(6)
  v_mfma_f32_16x16x32_bf16 v[36:39], v[96:99], a[36:39], v[36:39]
  ds_read_b128 v[92:95], v3 offset:10240
  s_add_u32 m0, s26, 122880
  s_add_u32 s53, s54, 40960
  buffer_load_dwordx4 v3, s[4:7], s53 offen lds
  v_lshlrev_b32 v76, 16, v76
  s_waitcnt lgkmcnt(6)
  v_mfma_f32_16x16x32_bf16 v[40:43], v[100:103], a[36:39], v[40:43]
  ds_read_b128 v[96:99], v3 offset:11264
  v_add_f32 v77, 0x3727c5ac, v77
  s_waitcnt lgkmcnt(6)
  v_mfma_f32_16x16x32_bf16 v[44:47], v[104:107], a[36:39], v[44:47]
  ds_read_b128 v[100:103], v3 offset:12288
  v_cvt_pk_bf16_f32 v77, v77, v77
  v_lshlrev_b32 v77, 16, v77
  s_waitcnt vmcnt(8) lgkmcnt(6)
  v_mfma_f32_16x16x32_bf16 v[20:23], v[108:111], a[40:43], v[20:23]
  ds_read_b128 v[104:107], v3 offset:13312
  buffer_load_dwordx4 a[64:67], v3, s[12:15], s25 offen sc1
  s_add_u32 s25, s25, 131072
  s_waitcnt lgkmcnt(6)
  v_mfma_f32_16x16x32_bf16 v[24:27], v[112:115], a[40:43], v[24:27]
  ds_read_b128 v[108:111], v3 offset:14336
  v_sqrt_f32 v77, v77
  s_waitcnt lgkmcnt(6)
  v_mfma_f32_16x16x32_bf16 v[28:31], v[84:87], a[40:43], v[28:31]
  ds_read_b128 v[112:115], v3 offset:15360
  v_cvt_pk_bf16_f32 v82, v77, v77
  v_lshlrev_b32 v82, 16, v82
  s_waitcnt lgkmcnt(6)
  v_mfma_f32_16x16x32_bf16 v[32:35], v[88:91], a[40:43], v[32:35]
  ds_read_b128 v[84:87], v3 offset:16384
  v_rcp_f32 v77, v82
  s_waitcnt lgkmcnt(6)
  v_mfma_f32_16x16x32_bf16 v[36:39], v[92:95], a[40:43], v[36:39]
  ds_read_b128 v[88:91], v3 offset:17408
  s_add_u32 m0, s26, 131072
  s_add_u32 s53, s54, 49152
  buffer_load_dwordx4 v3, s[4:7], s53 offen lds
  v_mul_f32 v80, 0xc0135761, v77
  s_waitcnt lgkmcnt(6)
  v_mfma_f32_16x16x32_bf16 v[40:43], v[96:99], a[40:43], v[40:43]
  ds_read_b128 v[92:95], v3 offset:18432
  v_mul_f32 v78, v77, v77
  s_waitcnt lgkmcnt(6)
  v_mfma_f32_16x16x32_bf16 v[44:47], v[100:103], a[40:43], v[44:47]
  ds_read_b128 v[96:99], v3 offset:19456
  v_mul_f32 v77, 0xbdd2d3e8, v77
  v_mul_f32 v81, v78, v77
  s_waitcnt vmcnt(9) lgkmcnt(6)
  v_mfma_f32_16x16x32_bf16 v[20:23], v[104:107], a[44:47], v[20:23]
  ds_read_b128 v[100:103], v3 offset:20480
  buffer_load_dwordx4 a[68:71], v3, s[12:15], s25 offen sc1
  s_add_u32 s25, s25, 131072
  s_waitcnt lgkmcnt(6)
  v_mfma_f32_16x16x32_bf16 v[24:27], v[108:111], a[44:47], v[24:27]
  ds_read_b128 v[104:107], v3 offset:21504
  s_lshl_b32 s37, s44, 17
  s_add_u32 s37, s37, s24
  s_waitcnt lgkmcnt(6)
  v_mfma_f32_16x16x32_bf16 v[28:31], v[112:115], a[44:47], v[28:31]
  ds_read_b128 v[108:111], v3 offset:22528
  s_waitcnt lgkmcnt(6)
  v_mfma_f32_16x16x32_bf16 v[32:35], v[84:87], a[44:47], v[32:35]
  ds_read_b128 v[112:115], v3 offset:23552
  s_add_u32 s38, s37, 131072
  s_add_u32 s39, s37, 262144
  s_waitcnt lgkmcnt(6)
  v_mfma_f32_16x16x32_bf16 v[36:39], v[88:91], a[44:47], v[36:39]
  ds_read_b128 v[84:87], v3 offset:24576
  s_lshl_b32 s35, s45, 17
  s_waitcnt lgkmcnt(6)
  v_mfma_f32_16x16x32_bf16 v[40:43], v[92:95], a[44:47], v[40:43]
  ds_read_b128 v[88:91], v3 offset:25600
  s_add_u32 m0, s26, 139264
  s_add_u32 s53, s54, 57344
  buffer_load_dwordx4 v3, s[4:7], s53 offen lds
  s_add_u32 s35, s35, s24
  s_waitcnt lgkmcnt(6)
  v_mfma_f32_16x16x32_bf16 v[44:47], v[96:99], a[44:47], v[44:47]
  ds_read_b128 v[92:95], v3 offset:26624
  s_lshl_b32 s46, s46, 4
  s_add_u32 s35, s35, s46
  s_waitcnt vmcnt(10) lgkmcnt(6)
  v_mfma_f32_16x16x32_bf16 v[20:23], v[100:103], a[48:51], v[20:23]
  ds_read_b128 v[96:99], v3 offset:27648
  s_waitcnt lgkmcnt(6)
  v_mfma_f32_16x16x32_bf16 v[24:27], v[104:107], a[48:51], v[24:27]
  ds_read_b128 v[100:103], v3 offset:28672
  s_waitcnt lgkmcnt(6)
  v_mfma_f32_16x16x32_bf16 v[28:31], v[108:111], a[48:51], v[28:31]
  ds_read_b128 v[104:107], v3 offset:29696
  buffer_load_dwordx4 a[72:75], v3, s[12:15], s25 offen sc1
  s_add_u32 s25, s25, 131072
  s_waitcnt lgkmcnt(6)
  v_mfma_f32_16x16x32_bf16 v[32:35], v[112:115], a[48:51], v[32:35]
  ds_read_b128 v[108:111], v3 offset:30720
  s_waitcnt lgkmcnt(6)
  v_mfma_f32_16x16x32_bf16 v[36:39], v[84:87], a[48:51], v[36:39]
  ds_read_b128 v[112:115], v3 offset:31744
  s_waitcnt lgkmcnt(6)
  v_mfma_f32_16x16x32_bf16 v[40:43], v[88:91], a[48:51], v[40:43]
  ds_read_b128 v[84:87], v3 offset:32768
  v_fma_f32 v20, v48, v76, v20
  v_fma_f32 v21, v49, v76, v21
  v_fma_f32 v22, v50, v76, v22
  v_fma_f32 v23, v51, v76, v23
  s_waitcnt lgkmcnt(6)
  v_mfma_f32_16x16x32_bf16 v[44:47], v[92:95], a[48:51], v[44:47]
  ds_read_b128 v[88:91], v3 offset:33792
  s_add_u32 m0, s26, 147456
  s_add_u32 s53, s54, 65536
  buffer_load_dwordx4 v3, s[4:7], s53 offen lds
  s_waitcnt vmcnt(11) lgkmcnt(6)
  v_mfma_f32_16x16x32_bf16 v[20:23], v[96:99], a[52:55], v[20:23]
  ds_read_b128 v[92:95], v3 offset:34816
  s_waitcnt lgkmcnt(6)
  v_mfma_f32_16x16x32_bf16 v[24:27], v[100:103], a[52:55], v[24:27]
  ds_read_b128 v[96:99], v3 offset:35840
  s_waitcnt lgkmcnt(6)
  v_mfma_f32_16x16x32_bf16 v[28:31], v[104:107], a[52:55], v[28:31]
  ds_read_b128 v[100:103], v3 offset:36864
  s_waitcnt lgkmcnt(6)
  v_mfma_f32_16x16x32_bf16 v[32:35], v[108:111], a[52:55], v[32:35]
  ds_read_b128 v[104:107], v3 offset:37888
  buffer_load_dwordx4 a[76:79], v3, s[12:15], s25 offen sc1
  s_waitcnt lgkmcnt(6)
  v_mfma_f32_16x16x32_bf16 v[36:39], v[112:115], a[52:55], v[36:39]
  ds_read_b128 v[108:111], v3 offset:38912
  s_waitcnt lgkmcnt(6)
  v_mfma_f32_16x16x32_bf16 v[40:43], v[84:87], a[52:55], v[40:43]
  ds_read_b128 v[112:115], v3 offset:39936
  s_waitcnt lgkmcnt(6)
  v_mfma_f32_16x16x32_bf16 v[44:47], v[88:91], a[52:55], v[44:47]
  ds_read_b128 v[84:87], v3 offset:40960
  v_fma_f32 v24, v52, v76, v24
  v_fma_f32 v25, v53, v76, v25
  v_fma_f32 v26, v54, v76, v26
  v_fma_f32 v27, v55, v76, v27
  s_barrier
  s_waitcnt vmcnt(10) lgkmcnt(6)
  v_mfma_f32_16x16x32_bf16 v[20:23], v[92:95], a[56:59], v[20:23]
  ds_read_b128 v[88:91], v3 offset:41984
  v_fma_f32 v28, v56, v76, v28
  v_fma_f32 v29, v57, v76, v29
  v_fma_f32 v30, v58, v76, v30
  v_fma_f32 v31, v59, v76, v31
  s_waitcnt lgkmcnt(6)
  v_mfma_f32_16x16x32_bf16 v[24:27], v[96:99], a[56:59], v[24:27]
  ds_read_b128 v[92:95], v3 offset:43008
  s_waitcnt lgkmcnt(6)
  v_mfma_f32_16x16x32_bf16 v[28:31], v[100:103], a[56:59], v[28:31]
  ds_read_b128 v[96:99], v3 offset:44032
  s_waitcnt lgkmcnt(6)
  v_mfma_f32_16x16x32_bf16 v[32:35], v[104:107], a[56:59], v[32:35]
  ds_read_b128 v[100:103], v3 offset:45056
  s_waitcnt lgkmcnt(6)
  v_mfma_f32_16x16x32_bf16 v[36:39], v[108:111], a[56:59], v[36:39]
  ds_read_b128 v[104:107], v3 offset:46080
  s_add_u32 m0, s26, 155648
  s_add_u32 s53, s54, 73728
  buffer_load_dwordx4 v3, s[4:7], s53 offen lds
  s_waitcnt lgkmcnt(6)
  v_mfma_f32_16x16x32_bf16 v[40:43], v[112:115], a[56:59], v[40:43]
  ds_read_b128 v[108:111], v3 offset:47104
  s_waitcnt lgkmcnt(6)
  v_mfma_f32_16x16x32_bf16 v[44:47], v[84:87], a[56:59], v[44:47]
  ds_read_b128 v[112:115], v3 offset:48128
  s_add_u32 m0, s26, 98304
  s_add_u32 s53, s54, 16384
  buffer_load_dwordx4 v3, s[4:7], s53 offen lds
  s_waitcnt vmcnt(10) lgkmcnt(6)
  v_mfma_f32_16x16x32_bf16 v[20:23], v[88:91], a[60:63], v[20:23]
  ds_read_b128 v[84:87], v3 offset:49152
  s_waitcnt lgkmcnt(6)
  v_mfma_f32_16x16x32_bf16 v[24:27], v[92:95], a[60:63], v[24:27]
  ds_read_b128 v[88:91], v3 offset:50176
  v_fma_f32 v32, v60, v76, v32
  v_fma_f32 v33, v61, v76, v33
  v_fma_f32 v34, v62, v76, v34
  v_fma_f32 v35, v63, v76, v35
  s_waitcnt lgkmcnt(6)
  v_mfma_f32_16x16x32_bf16 v[28:31], v[96:99], a[60:63], v[28:31]
  ds_read_b128 v[92:95], v3 offset:51200
  s_waitcnt lgkmcnt(6)
  v_mfma_f32_16x16x32_bf16 v[32:35], v[100:103], a[60:63], v[32:35]
  ds_read_b128 v[96:99], v3 offset:52224
  s_waitcnt lgkmcnt(6)
  v_mfma_f32_16x16x32_bf16 v[36:39], v[104:107], a[60:63], v[36:39]
  ds_read_b128 v[100:103], v3 offset:53248
  s_add_u32 m0, s26, 0
  s_add_u32 s53, s54, 81920
  buffer_load_dwordx4 v3, s[4:7], s53 offen lds
  s_waitcnt lgkmcnt(6)
  v_mfma_f32_16x16x32_bf16 v[40:43], v[108:111], a[60:63], v[40:43]
  ds_read_b128 v[104:107], v3 offset:54272
  s_waitcnt lgkmcnt(6)
  v_mfma_f32_16x16x32_bf16 v[44:47], v[112:115], a[60:63], v[44:47]
  ds_read_b128 v[108:111], v3 offset:55296
  s_add_u32 m0, s26, 8192
  s_add_u32 s53, s54, 90112
  buffer_load_dwordx4 v3, s[4:7], s53 offen lds
  s_waitcnt vmcnt(10) lgkmcnt(6)
  v_mfma_f32_16x16x32_bf16 v[20:23], v[84:87], a[64:67], v[20:23]
  ds_read_b128 v[112:115], v3 offset:56320
  s_waitcnt lgkmcnt(6)
  v_mfma_f32_16x16x32_bf16 v[24:27], v[88:91], a[64:67], v[24:27]
  ds_read_b128 v[84:87], v3 offset:57344
  s_waitcnt lgkmcnt(6)
  v_mfma_f32_16x16x32_bf16 v[28:31], v[92:95], a[64:67], v[28:31]
  ds_read_b128 v[88:91], v3 offset:58368
  v_fma_f32 v36, v64, v76, v36
  v_fma_f32 v37, v65, v76, v37
  v_fma_f32 v38, v66, v76, v38
  v_fma_f32 v39, v67, v76, v39
  s_waitcnt lgkmcnt(6)
  v_mfma_f32_16x16x32_bf16 v[32:35], v[96:99], a[64:67], v[32:35]
  ds_read_b128 v[92:95], v3 offset:59392
  s_waitcnt lgkmcnt(6)
  v_mfma_f32_16x16x32_bf16 v[36:39], v[100:103], a[64:67], v[36:39]
  ds_read_b128 v[96:99], v3 offset:60416
  s_add_u32 m0, s26, 16384
  s_add_u32 s53, s54, 98304
  buffer_load_dwordx4 v3, s[4:7], s53 offen lds
  s_waitcnt lgkmcnt(6)
  v_mfma_f32_16x16x32_bf16 v[40:43], v[104:107], a[64:67], v[40:43]
  ds_read_b128 v[100:103], v3 offset:61440
  s_waitcnt lgkmcnt(6)
  v_mfma_f32_16x16x32_bf16 v[44:47], v[108:111], a[64:67], v[44:47]
  ds_read_b128 v[104:107], v3 offset:62464
  s_add_u32 m0, s26, 24576
  s_add_u32 s53, s54, 106496
  buffer_load_dwordx4 v3, s[4:7], s53 offen lds
  s_waitcnt vmcnt(10) lgkmcnt(6)
  v_mfma_f32_16x16x32_bf16 v[20:23], v[112:115], a[68:71], v[20:23]
  ds_read_b128 v[108:111], v3 offset:63488
  s_waitcnt lgkmcnt(6)
  v_mfma_f32_16x16x32_bf16 v[24:27], v[84:87], a[68:71], v[24:27]
  ds_read_b128 v[112:115], v3 offset:64512
  s_waitcnt lgkmcnt(6)
  v_mfma_f32_16x16x32_bf16 v[28:31], v[88:91], a[68:71], v[28:31]
  ds_read_b128 v[84:87], v116 offset:0
  s_waitcnt lgkmcnt(6)
  v_mfma_f32_16x16x32_bf16 v[32:35], v[92:95], a[68:71], v[32:35]
  ds_read_b128 v[88:91], v116 offset:1024
  v_fma_f32 v40, v68, v76, v40
  v_fma_f32 v41, v69, v76, v41
  v_fma_f32 v42, v70, v76, v42
  v_fma_f32 v43, v71, v76, v43
  s_waitcnt lgkmcnt(6)
  v_mfma_f32_16x16x32_bf16 v[36:39], v[96:99], a[68:71], v[36:39]
  ds_read_b128 v[92:95], v116 offset:2048
  s_waitcnt lgkmcnt(6)
  v_mfma_f32_16x16x32_bf16 v[40:43], v[100:103], a[68:71], v[40:43]
  ds_read_b128 v[96:99], v116 offset:3072
  s_waitcnt lgkmcnt(6)
  v_mfma_f32_16x16x32_bf16 v[44:47], v[104:107], a[68:71], v[44:47]
  ds_read_b128 v[100:103], v116 offset:4096
  s_waitcnt vmcnt(8) lgkmcnt(6)
  v_mfma_f32_16x16x32_bf16 v[20:23], v[108:111], a[72:75], v[20:23]
  ds_read_b128 v[104:107], v116 offset:5120
  s_waitcnt lgkmcnt(6)
  v_mfma_f32_16x16x32_bf16 v[24:27], v[112:115], a[72:75], v[24:27]
  ds_read_b128 v[108:111], v116 offset:6144
  s_waitcnt lgkmcnt(6)
  v_mfma_f32_16x16x32_bf16 v[28:31], v[84:87], a[72:75], v[28:31]
  ds_read_b128 v[112:115], v116 offset:7168
  s_waitcnt lgkmcnt(6)
  v_mfma_f32_16x16x32_bf16 v[32:35], v[88:91], a[72:75], v[32:35]
  ds_read_b128 v[84:87], v116 offset:8192
  s_waitcnt lgkmcnt(6)
  v_mfma_f32_16x16x32_bf16 v[36:39], v[92:95], a[72:75], v[36:39]
  ds_read_b128 v[88:91], v116 offset:9216
  v_fma_f32 v44, v72, v76, v44
  v_fma_f32 v45, v73, v76, v45
  v_fma_f32 v46, v74, v76, v46
  v_fma_f32 v47, v75, v76, v47
  s_waitcnt lgkmcnt(6)
  v_mfma_f32_16x16x32_bf16 v[40:43], v[96:99], a[72:75], v[40:43]
  ds_read_b128 v[92:95], v116 offset:10240
  s_waitcnt lgkmcnt(6)
  v_mfma_f32_16x16x32_bf16 v[44:47], v[100:103], a[72:75], v[44:47]
  ds_read_b128 v[96:99], v116 offset:11264
  s_waitcnt vmcnt(6) lgkmcnt(6)
  v_mfma_f32_16x16x32_bf16 v[20:23], v[104:107], a[76:79], v[20:23]
  s_waitcnt lgkmcnt(5)
  v_mfma_f32_16x16x32_bf16 v[24:27], v[108:111], a[76:79], v[24:27]
  s_waitcnt lgkmcnt(4)
  v_mfma_f32_16x16x32_bf16 v[28:31], v[112:115], a[76:79], v[28:31]
  s_waitcnt lgkmcnt(3)
  v_mfma_f32_16x16x32_bf16 v[32:35], v[84:87], a[76:79], v[32:35]
  s_waitcnt lgkmcnt(2)
  v_mfma_f32_16x16x32_bf16 v[36:39], v[88:91], a[76:79], v[36:39]
  s_waitcnt lgkmcnt(1)
  v_mfma_f32_16x16x32_bf16 v[40:43], v[92:95], a[76:79], v[40:43]
  s_waitcnt lgkmcnt(0)
  v_mfma_f32_16x16x32_bf16 v[44:47], v[96:99], a[76:79], v[44:47]
  v_mul_f32 v84, v20, v20
  v_mul_f32 v85, v21, v21
  v_mul_f32 v86, v22, v22
  v_mul_f32 v87, v23, v23
  v_mul_f32 v88, v24, v24
  v_mul_f32 v89, v25, v25
  v_mul_f32 v90, v26, v26
  v_mul_f32 v91, v27, v27
  v_fma_f32 v84, v84, v81, v80
  v_fma_f32 v85, v85, v81, v80
  v_fma_f32 v86, v86, v81, v80
  v_fma_f32 v87, v87, v81, v80
  v_fma_f32 v88, v88, v81, v80
  v_fma_f32 v89, v89, v81, v80
  v_fma_f32 v90, v90, v81, v80
  v_fma_f32 v91, v91, v81, v80
  v_mul_f32 v84, v84, v20
  v_mul_f32 v85, v85, v21
  v_mul_f32 v86, v86, v22
  v_mul_f32 v87, v87, v23
  v_mul_f32 v88, v88, v24
  v_mul_f32 v89, v89, v25
  v_mul_f32 v90, v90, v26
  v_mul_f32 v91, v91, v27
  v_exp_f32 v84, v84
  v_exp_f32 v85, v85
  v_exp_f32 v86, v86
  v_exp_f32 v87, v87
  v_exp_f32 v88, v88
  v_exp_f32 v89, v89
  v_exp_f32 v90, v90
  v_exp_f32 v91, v91
  v_fma_f32 v84, v84, v82, v82
  v_fma_f32 v85, v85, v82, v82
  v_fma_f32 v86, v86, v82, v82
  v_fma_f32 v87, v87, v82, v82
  v_fma_f32 v88, v88, v82, v82
  v_fma_f32 v89, v89, v82, v82
  v_fma_f32 v90, v90, v82, v82
  v_fma_f32 v91, v91, v82, v82
  v_rcp_f32 v84, v84
  v_rcp_f32 v85, v85
  v_rcp_f32 v86, v86
  v_rcp_f32 v87, v87
  v_rcp_f32 v88, v88
  v_rcp_f32 v89, v89
  v_rcp_f32 v90, v90
  v_rcp_f32 v91, v91
  v_mul_f32 v20, v20, v84
  v_mul_f32 v21, v21, v85
  v_mul_f32 v22, v22, v86
  v_mul_f32 v23, v23, v87
  v_mul_f32 v24, v24, v88
  v_mul_f32 v25, v25, v89
  v_mul_f32 v26, v26, v90
  v_mul_f32 v27, v27, v91
  v_cvt_pk_bf16_f32 v92, v20, v24
  v_cvt_pk_bf16_f32 v93, v21, v25
  v_cvt_pk_bf16_f32 v94, v22, v26
  v_cvt_pk_bf16_f32 v95, v23, v27
  buffer_store_dwordx4 v[92:95], v3, s[8:11], s37 offen sc1
  v_mul_f32 v84, v28, v28
  v_mul_f32 v85, v29, v29
  v_mul_f32 v86, v30, v30
  v_mul_f32 v87, v31, v31
  v_mul_f32 v88, v32, v32
  v_mul_f32 v89, v33, v33
  v_mul_f32 v90, v34, v34
  v_mul_f32 v91, v35, v35
  v_fma_f32 v84, v84, v81, v80
  v_fma_f32 v85, v85, v81, v80
  v_fma_f32 v86, v86, v81, v80
  v_fma_f32 v87, v87, v81, v80
  v_fma_f32 v88, v88, v81, v80
  v_fma_f32 v89, v89, v81, v80
  v_fma_f32 v90, v90, v81, v80
  v_fma_f32 v91, v91, v81, v80
  v_mul_f32 v84, v84, v28
  v_mul_f32 v85, v85, v29
  v_mul_f32 v86, v86, v30
  v_mul_f32 v87, v87, v31
  v_mul_f32 v88, v88, v32
  v_mul_f32 v89, v89, v33
  v_mul_f32 v90, v90, v34
  v_mul_f32 v91, v91, v35
  v_exp_f32 v84, v84
  v_exp_f32 v85, v85
  v_exp_f32 v86, v86
  v_exp_f32 v87, v87
  v_exp_f32 v88, v88
  v_exp_f32 v89, v89
  v_exp_f32 v90, v90
  v_exp_f32 v91, v91
  v_fma_f32 v84, v84, v82, v82
  v_fma_f32 v85, v85, v82, v82
  v_fma_f32 v86, v86, v82, v82
  v_fma_f32 v87, v87, v82, v82
  v_fma_f32 v88, v88, v82, v82
  v_fma_f32 v89, v89, v82, v82
  v_fma_f32 v90, v90, v82, v82
  v_fma_f32 v91, v91, v82, v82
  v_rcp_f32 v84, v84
  v_rcp_f32 v85, v85
  v_rcp_f32 v86, v86
  v_rcp_f32 v87, v87
  v_rcp_f32 v88, v88
  v_rcp_f32 v89, v89
  v_rcp_f32 v90, v90
  v_rcp_f32 v91, v91
  v_mul_f32 v28, v28, v84
  v_mul_f32 v29, v29, v85
  v_mul_f32 v30, v30, v86
  v_mul_f32 v31, v31, v87
  v_mul_f32 v32, v32, v88
  v_mul_f32 v33, v33, v89
  v_mul_f32 v34, v34, v90
  v_mul_f32 v35, v35, v91
  v_cvt_pk_bf16_f32 v96, v28, v32
  v_cvt_pk_bf16_f32 v97, v29, v33
  v_cvt_pk_bf16_f32 v98, v30, v34
  v_cvt_pk_bf16_f32 v99, v31, v35
  buffer_store_dwordx4 v[96:99], v3, s[8:11], s38 offen sc1
  v_mul_f32 v84, v36, v36
  v_mul_f32 v85, v37, v37
  v_mul_f32 v86, v38, v38
  v_mul_f32 v87, v39, v39
  v_mul_f32 v88, v40, v40
  v_mul_f32 v89, v41, v41
  v_mul_f32 v90, v42, v42
  v_mul_f32 v91, v43, v43
  v_fma_f32 v84, v84, v81, v80
  v_fma_f32 v85, v85, v81, v80
  v_fma_f32 v86, v86, v81, v80
  v_fma_f32 v87, v87, v81, v80
  v_fma_f32 v88, v88, v81, v80
  v_fma_f32 v89, v89, v81, v80
  v_fma_f32 v90, v90, v81, v80
  v_fma_f32 v91, v91, v81, v80
  v_mul_f32 v84, v84, v36
  v_mul_f32 v85, v85, v37
  v_mul_f32 v86, v86, v38
  v_mul_f32 v87, v87, v39
  v_mul_f32 v88, v88, v40
  v_mul_f32 v89, v89, v41
  v_mul_f32 v90, v90, v42
  v_mul_f32 v91, v91, v43
  v_exp_f32 v84, v84
  v_exp_f32 v85, v85
  v_exp_f32 v86, v86
  v_exp_f32 v87, v87
  v_exp_f32 v88, v88
  v_exp_f32 v89, v89
  v_exp_f32 v90, v90
  v_exp_f32 v91, v91
  v_fma_f32 v84, v84, v82, v82
  v_fma_f32 v85, v85, v82, v82
  v_fma_f32 v86, v86, v82, v82
  v_fma_f32 v87, v87, v82, v82
  v_fma_f32 v88, v88, v82, v82
  v_fma_f32 v89, v89, v82, v82
  v_fma_f32 v90, v90, v82, v82
  v_fma_f32 v91, v91, v82, v82
  v_rcp_f32 v84, v84
  v_rcp_f32 v85, v85
  v_rcp_f32 v86, v86
  v_rcp_f32 v87, v87
  v_rcp_f32 v88, v88
  v_rcp_f32 v89, v89
  v_rcp_f32 v90, v90
  v_rcp_f32 v91, v91
  v_mul_f32 v36, v36, v84
  v_mul_f32 v37, v37, v85
  v_mul_f32 v38, v38, v86
  v_mul_f32 v39, v39, v87
  v_mul_f32 v40, v40, v88
  v_mul_f32 v41, v41, v89
  v_mul_f32 v42, v42, v90
  v_mul_f32 v43, v43, v91
  v_cvt_pk_bf16_f32 v100, v36, v40
  v_cvt_pk_bf16_f32 v101, v37, v41
  v_cvt_pk_bf16_f32 v102, v38, v42
  v_cvt_pk_bf16_f32 v103, v39, v43
  buffer_store_dwordx4 v[100:103], v3, s[8:11], s39 offen sc1
  v_mul_f32 v84, v44, v44
  v_mul_f32 v85, v45, v45
  v_mul_f32 v86, v46, v46
  v_mul_f32 v87, v47, v47
  v_fma_f32 v84, v84, v81, v80
  v_fma_f32 v85, v85, v81, v80
  v_fma_f32 v86, v86, v81, v80
  v_fma_f32 v87, v87, v81, v80
  v_mul_f32 v84, v84, v44
  v_mul_f32 v85, v85, v45
  v_mul_f32 v86, v86, v46
  v_mul_f32 v87, v87, v47
  v_exp_f32 v84, v84
  v_exp_f32 v85, v85
  v_exp_f32 v86, v86
  v_exp_f32 v87, v87
  v_fma_f32 v84, v84, v82, v82
  v_fma_f32 v85, v85, v82, v82
  v_fma_f32 v86, v86, v82, v82
  v_fma_f32 v87, v87, v82, v82
  v_rcp_f32 v84, v84
  v_rcp_f32 v85, v85
  v_rcp_f32 v86, v86
  v_rcp_f32 v87, v87
  v_mul_f32 v44, v44, v84
  v_mul_f32 v45, v45, v85
  v_mul_f32 v46, v46, v86
  v_mul_f32 v47, v47, v87
  v_cvt_pk_bf16_f32 v104, v44, v45
  v_cvt_pk_bf16_f32 v105, v46, v47
  buffer_store_dwordx2 v[104:105], v6, s[8:11], s35 offen sc1
  s_lshl_b32 s24, s19, 17
  s_add_u32 s24, s24, s23
  s_waitcnt vmcnt(0)
  s_barrier
  s_cmp_lg_u32 s20, 0
  s_cbranch_scc1 .Lkf_kernel_np14
  v_mov_b32 v5, 1
  buffer_atomic_add v5, v7, s[56:59], s60 offen offset:128 sc1
.Lkf_kernel_np14:
  s_nop 1
  s_add_u32 m0, s26, 32768
  s_add_u32 s53, s54, 114688
  buffer_load_dwordx4 v3, s[4:7], s53 offen lds
  s_add_u32 m0, s26, 40960
  s_add_u32 s53, s54, 122880
  buffer_load_dwordx4 v3, s[4:7], s53 offen lds
  s_add_u32 m0, s26, 49152
  s_add_u32 s53, s54, 131072
  buffer_load_dwordx4 v3, s[4:7], s53 offen lds
  s_add_u32 m0, s26, 57344
  s_add_u32 s53, s54, 139264
  buffer_load_dwordx4 v3, s[4:7], s53 offen lds
  s_add_u32 m0, s26, 65536
  s_add_u32 s53, s54, 147456
  buffer_load_dwordx4 v3, s[4:7], s53 offen lds
  s_add_u32 m0, s26, 73728
  s_add_u32 s53, s54, 155648
  buffer_load_dwordx4 v3, s[4:7], s53 offen lds
  s_cmp_lg_u32 s20, 0
  s_cbranch_scc1 .Lkf_kernel_done13
  s_mov_b32 s62, 0x4000
.Lkf_kernel_spin12:
  buffer_load_dword v5, v7, s[56:59], s60 offen offset:128 sc1
  s_waitcnt vmcnt(0)
  v_readfirstlane_b32 s61, v5
  s_sub_u32 s62, s62, 1
  s_cselect_b32 s61, 16, s61
  s_cmp_lt_u32 s61, 16
  s_cbranch_scc1 .Lkf_kernel_spin12
.Lkf_kernel_done13:
  s_barrier
  buffer_load_dwordx4 a[0:3], v3, s[8:11], s24 offen sc1
  s_add_u32 s24, s24, 262144
  buffer_load_dwordx4 a[4:7], v3, s[8:11], s24 offen sc1
  s_add_u32 s24, s24, 262144
  buffer_load_dwordx4 a[8:11], v3, s[8:11], s24 offen sc1
  s_add_u32 s24, s24, 262144
  buffer_load_dwordx4 a[12:15], v3, s[8:11], s24 offen sc1
  s_add_u32 s24, s24, 262144
  buffer_load_dwordx4 a[16:19], v3, s[8:11], s24 offen sc1
  s_add_u32 s24, s24, 262144
  buffer_load_dwordx4 a[20:23], v3, s[8:11], s24 offen sc1
  s_add_u32 s24, s24, 262144
  s_mul_i32 s37, s19, 7168
  s_mul_i32 s38, s19, 3072
  s_add_u32 s38, s38, 2048
  s_mul_i32 s39, s19, 5120
  s_add_u32 s39, s39, 4096
  v_add_u32 v80, s37, v3
  v_add_u32 v83, 0xf000, v80
  v_add_u32 v86, 0x1e000, v80
  v_add_u32 v81, s38, v3
  v_add_u32 v84, 0xf000, v81
  v_add_u32 v87, 0x1e000, v81
  v_add_u32 v82, s39, v3
  v_add_u32 v85, 0xf000, v82
  v_add_u32 v88, 0x1e000, v82
  v_add_u32 v90, s26, v3
  v_add_u32 v91, 0x14000, v90
  v_add_u32 v92, 0x1e000, v90
  ds_read_b128 v[48:51], v84 offset:20480
  ds_read_b128 v[52:55], v84 offset:21504
  buffer_load_dwordx4 a[24:27], v3, s[8:11], s24 offen sc1
  s_add_u32 s24, s24, 262144
  ds_read_b128 v[56:59], v85 offset:20480
  ds_read_b128 v[40:43], v83 offset:20480
  ds_read_b128 v[44:47], v83 offset:21504
  s_waitcnt vmcnt(6) lgkmcnt(4)
  v_mfma_f32_16x16x32_bf16 v[28:31], v[48:51], a[0:3], 0
  ds_read_b128 v[68:71], v84 offset:30720
  s_waitcnt lgkmcnt(4)
  v_mfma_f32_16x16x32_bf16 v[32:35], v[52:55], a[0:3], 0
  ds_read_b128 v[72:75], v84 offset:31744
  s_waitcnt lgkmcnt(4)
  v_mfma_f32_16x16x32_bf16 v[36:39], v[56:59], a[0:3], 0
  buffer_load_dwordx4 a[28:31], v3, s[8:11], s24 offen sc1
  s_add_u32 s24, s24, 262144
  s_waitcnt lgkmcnt(3)
  v_mfma_f32_16x16x32_bf16 v[20:23], v[40:43], a[0:3], 0
  ds_read_b128 v[76:79], v85 offset:30720
  s_waitcnt lgkmcnt(3)
  v_mfma_f32_16x16x32_bf16 v[24:27], v[44:47], a[0:3], 0
  ds_read_b128 v[60:63], v83 offset:30720
  ds_read_b128 v[64:67], v83 offset:31744
  s_waitcnt vmcnt(6) lgkmcnt(4)
  v_mfma_f32_16x16x32_bf16 v[28:31], v[68:71], a[4:7], v[28:31]
  ds_read_b128 v[48:51], v84 offset:40960
  s_waitcnt lgkmcnt(4)
  v_mfma_f32_16x16x32_bf16 v[32:35], v[72:75], a[4:7], v[32:35]
  ds_read_b128 v[52:55], v84 offset:41984
  s_waitcnt lgkmcnt(4)
  v_mfma_f32_16x16x32_bf16 v[36:39], v[76:79], a[4:7], v[36:39]
  buffer_load_dwordx4 a[32:35], v3, s[8:11], s24 offen sc1
  s_add_u32 s24, s24, 262144
  s_waitcnt lgkmcnt(3)
  v_mfma_f32_16x16x32_bf16 v[20:23], v[60:63], a[4:7], v[20:23]
  ds_read_b128 v[56:59], v85 offset:40960
  s_waitcnt lgkmcnt(3)
  v_mfma_f32_16x16x32_bf16 v[24:27], v[64:67], a[4:7], v[24:27]
  ds_read_b128 v[40:43], v83 offset:40960
  ds_read_b128 v[44:47], v83 offset:41984
  s_waitcnt vmcnt(6) lgkmcnt(4)
  v_mfma_f32_16x16x32_bf16 v[28:31], v[48:51], a[8:11], v[28:31]
  ds_read_b128 v[68:71], v84 offset:51200
  s_waitcnt lgkmcnt(4)
  v_mfma_f32_16x16x32_bf16 v[32:35], v[52:55], a[8:11], v[32:35]
  ds_read_b128 v[72:75], v84 offset:52224
  s_waitcnt lgkmcnt(4)
  v_mfma_f32_16x16x32_bf16 v[36:39], v[56:59], a[8:11], v[36:39]
  buffer_load_dwordx4 a[36:39], v3, s[8:11], s24 offen sc1
  s_add_u32 s24, s24, 262144
  s_waitcnt lgkmcnt(3)
  v_mfma_f32_16x16x32_bf16 v[20:23], v[40:43], a[8:11], v[20:23]
  ds_read_b128 v[76:79], v85 offset:51200
  s_waitcnt lgkmcnt(3)
  v_mfma_f32_16x16x32_bf16 v[24:27], v[44:47], a[8:11], v[24:27]
  ds_read_b128 v[60:63], v83 offset:51200
  ds_read_b128 v[64:67], v83 offset:52224
  s_waitcnt vmcnt(6) lgkmcnt(4)
  v_mfma_f32_16x16x32_bf16 v[28:31], v[68:71], a[12:15], v[28:31]
  ds_read_b128 v[48:51], v87 offset:0
  s_waitcnt lgkmcnt(4)
  v_mfma_f32_16x16x32_bf16 v[32:35], v[72:75], a[12:15], v[32:35]
  ds_read_b128 v[52:55], v87 offset:1024
  s_waitcnt lgkmcnt(4)
  v_mfma_f32_16x16x32_bf16 v[36:39], v[76:79], a[12:15], v[36:39]
  buffer_load_dwordx4 a[40:43], v3, s[8:11], s24 offen sc1
  s_add_u32 s24, s24, 262144
  s_waitcnt lgkmcnt(3)
  v_mfma_f32_16x16x32_bf16 v[20:23], v[60:63], a[12:15], v[20:23]
  ds_read_b128 v[56:59], v88 offset:0
  s_waitcnt lgkmcnt(3)
  v_mfma_f32_16x16x32_bf16 v[24:27], v[64:67], a[12:15], v[24:27]
  ds_read_b128 v[40:43], v86 offset:0
  ds_read_b128 v[44:47], v86 offset:1024
  s_waitcnt vmcnt(6) lgkmcnt(4)
  v_mfma_f32_16x16x32_bf16 v[28:31], v[48:51], a[16:19], v[28:31]
  ds_read_b128 v[68:71], v87 offset:10240
  s_waitcnt lgkmcnt(4)
  v_mfma_f32_16x16x32_bf16 v[32:35], v[52:55], a[16:19], v[32:35]
  ds_read_b128 v[72:75], v87 offset:11264
  s_waitcnt lgkmcnt(4)
  v_mfma_f32_16x16x32_bf16 v[36:39], v[56:59], a[16:19], v[36:39]
  buffer_load_dwordx4 a[44:47], v3, s[8:11], s24 offen sc1
  s_add_u32 s24, s24, 262144
  s_waitcnt lgkmcnt(3)
  v_mfma_f32_16x16x32_bf16 v[20:23], v[40:43], a[16:19], v[20:23]
  ds_read_b128 v[76:79], v88 offset:10240
  s_waitcnt lgkmcnt(3)
  v_mfma_f32_16x16x32_bf16 v[24:27], v[44:47], a[16:19], v[24:27]
  ds_read_b128 v[60:63], v86 offset:10240
  ds_read_b128 v[64:67], v86 offset:11264
  s_waitcnt vmcnt(6) lgkmcnt(4)
  v_mfma_f32_16x16x32_bf16 v[28:31], v[68:71], a[20:23], v[28:31]
  ds_read_b128 v[48:51], v87 offset:20480
  s_waitcnt lgkmcnt(4)
  v_mfma_f32_16x16x32_bf16 v[32:35], v[72:75], a[20:23], v[32:35]
  ds_read_b128 v[52:55], v87 offset:21504
  s_waitcnt lgkmcnt(4)
  v_mfma_f32_16x16x32_bf16 v[36:39], v[76:79], a[20:23], v[36:39]
  buffer_load_dwordx4 a[48:51], v3, s[8:11], s24 offen sc1
  s_add_u32 s24, s24, 262144
  s_waitcnt lgkmcnt(3)
  v_mfma_f32_16x16x32_bf16 v[20:23], v[60:63], a[20:23], v[20:23]
  ds_read_b128 v[56:59], v88 offset:20480
  s_waitcnt lgkmcnt(3)
  v_mfma_f32_16x16x32_bf16 v[24:27], v[64:67], a[20:23], v[24:27]
  ds_read_b128 v[40:43], v86 offset:20480
  ds_read_b128 v[44:47], v86 offset:21504
  s_waitcnt vmcnt(6) lgkmcnt(4)
  v_mfma_f32_16x16x32_bf16 v[28:31], v[48:51], a[24:27], v[28:31]
  ds_read_b128 v[68:71], v87 offset:30720
  s_waitcnt lgkmcnt(4)
  v_mfma_f32_16x16x32_bf16 v[32:35], v[52:55], a[24:27], v[32:35]
  ds_read_b128 v[72:75], v87 offset:31744
  s_waitcnt lgkmcnt(4)
  v_mfma_f32_16x16x32_bf16 v[36:39], v[56:59], a[24:27], v[36:39]
  buffer_load_dwordx4 a[52:55], v3, s[8:11], s24 offen sc1
  s_add_u32 s24, s24, 262144
  s_waitcnt lgkmcnt(3)
  v_mfma_f32_16x16x32_bf16 v[20:23], v[40:43], a[24:27], v[20:23]
  ds_read_b128 v[76:79], v88 offset:30720
  s_waitcnt lgkmcnt(3)
  v_mfma_f32_16x16x32_bf16 v[24:27], v[44:47], a[24:27], v[24:27]
  ds_read_b128 v[60:63], v86 offset:30720
  ds_read_b128 v[64:67], v86 offset:31744
  s_barrier
  s_waitcnt vmcnt(6) lgkmcnt(4)
  v_mfma_f32_16x16x32_bf16 v[28:31], v[68:71], a[28:31], v[28:31]
  ds_read_b128 v[48:51], v81 offset:0
  s_waitcnt lgkmcnt(4)
  v_mfma_f32_16x16x32_bf16 v[32:35], v[72:75], a[28:31], v[32:35]
  ds_read_b128 v[52:55], v81 offset:1024
  s_waitcnt lgkmcnt(4)
  v_mfma_f32_16x16x32_bf16 v[36:39], v[76:79], a[28:31], v[36:39]
  buffer_load_dwordx4 a[56:59], v3, s[8:11], s24 offen sc1
  s_add_u32 s24, s24, 262144
  s_waitcnt lgkmcnt(3)
  v_mfma_f32_16x16x32_bf16 v[20:23], v[60:63], a[28:31], v[20:23]
  ds_read_b128 v[56:59], v82 offset:0
  s_waitcnt lgkmcnt(3)
  v_mfma_f32_16x16x32_bf16 v[24:27], v[64:67], a[28:31], v[24:27]
  ds_read_b128 v[40:43], v80 offset:0
  ds_read_b128 v[44:47], v80 offset:1024
  s_waitcnt vmcnt(6) lgkmcnt(4)
  v_mfma_f32_16x16x32_bf16 v[28:31], v[48:51], a[32:35], v[28:31]
  ds_read_b128 v[68:71], v81 offset:10240
  s_waitcnt lgkmcnt(4)
  v_mfma_f32_16x16x32_bf16 v[32:35], v[52:55], a[32:35], v[32:35]
  ds_read_b128 v[72:75], v81 offset:11264
  s_waitcnt lgkmcnt(4)
  v_mfma_f32_16x16x32_bf16 v[36:39], v[56:59], a[32:35], v[36:39]
  buffer_load_dwordx4 a[60:63], v3, s[8:11], s24 offen sc1
  s_add_u32 s24, s24, 262144
  s_waitcnt lgkmcnt(3)
  v_mfma_f32_16x16x32_bf16 v[20:23], v[40:43], a[32:35], v[20:23]
  ds_read_b128 v[76:79], v82 offset:10240
  s_waitcnt lgkmcnt(3)
  v_mfma_f32_16x16x32_bf16 v[24:27], v[44:47], a[32:35], v[24:27]
  ds_read_b128 v[60:63], v80 offset:10240
  ds_read_b128 v[64:67], v80 offset:11264
  s_barrier
  s_waitcnt vmcnt(6) lgkmcnt(4)
  v_mfma_f32_16x16x32_bf16 v[28:31], v[68:71], a[36:39], v[28:31]
  ds_read_b128 v[48:51], v81 offset:20480
  s_waitcnt lgkmcnt(4)
  v_mfma_f32_16x16x32_bf16 v[32:35], v[72:75], a[36:39], v[32:35]
  ds_read_b128 v[52:55], v81 offset:21504
  s_waitcnt lgkmcnt(4)
  v_mfma_f32_16x16x32_bf16 v[36:39], v[76:79], a[36:39], v[36:39]
  s_add_u32 m0, s26, 81920
  s_add_u32 s53, s54, 163840
  buffer_load_dwordx4 v3, s[4:7], s53 offen lds
  ds_read_b128 v[56:59], v82 offset:20480
  s_waitcnt lgkmcnt(4)
  v_mfma_f32_16x16x32_bf16 v[20:23], v[60:63], a[36:39], v[20:23]
  ds_read_b128 v[40:43], v80 offset:20480
  s_waitcnt lgkmcnt(4)
  v_mfma_f32_16x16x32_bf16 v[24:27], v[64:67], a[36:39], v[24:27]
  s_add_u32 m0, s26, 90112
  s_add_u32 s53, s54, 172032
  buffer_load_dwordx4 v3, s[4:7], s53 offen lds
  ds_read_b128 v[44:47], v80 offset:21504
  buffer_load_dwordx4 a[64:67], v3, s[8:11], s24 offen sc1
  s_add_u32 s24, s24, 262144
  s_waitcnt vmcnt(8) lgkmcnt(4)
  v_mfma_f32_16x16x32_bf16 v[28:31], v[48:51], a[40:43], v[28:31]
  ds_read_b128 v[68:71], v81 offset:30720
  s_waitcnt lgkmcnt(4)
  v_mfma_f32_16x16x32_bf16 v[32:35], v[52:55], a[40:43], v[32:35]
  ds_read_b128 v[72:75], v81 offset:31744
  s_waitcnt lgkmcnt(4)
  v_mfma_f32_16x16x32_bf16 v[36:39], v[56:59], a[40:43], v[36:39]
  s_add_u32 m0, s26, 98304
  s_add_u32 s53, s54, 180224
  buffer_load_dwordx4 v3, s[4:7], s53 offen lds
  s_waitcnt lgkmcnt(3)
  v_mfma_f32_16x16x32_bf16 v[20:23], v[40:43], a[40:43], v[20:23]
  ds_read_b128 v[76:79], v82 offset:30720
  ds_read_b128 v[60:63], v80 offset:30720
  s_waitcnt lgkmcnt(4)
  v_mfma_f32_16x16x32_bf16 v[24:27], v[44:47], a[40:43], v[24:27]
  buffer_load_dwordx4 a[68:71], v3, s[8:11], s24 offen sc1
  s_add_u32 s24, s24, 262144
  ds_read_b128 v[64:67], v80 offset:31744
  s_barrier
  s_waitcnt vmcnt(9) lgkmcnt(4)
  v_mfma_f32_16x16x32_bf16 v[28:31], v[68:71], a[44:47], v[28:31]
  ds_read_b128 v[48:51], v81 offset:40960
  s_waitcnt lgkmcnt(4)
  v_mfma_f32_16x16x32_bf16 v[32:35], v[72:75], a[44:47], v[32:35]
  ds_read_b128 v[52:55], v81 offset:41984
  s_waitcnt lgkmcnt(4)
  v_mfma_f32_16x16x32_bf16 v[36:39], v[76:79], a[44:47], v[36:39]
  s_add_u32 m0, s26, 106496
  s_add_u32 s53, s54, 188416
  buffer_load_dwordx4 v3, s[4:7], s53 offen lds
  s_waitcnt lgkmcnt(3)
  v_mfma_f32_16x16x32_bf16 v[20:23], v[60:63], a[44:47], v[20:23]
  ds_read_b128 v[56:59], v82 offset:40960
  ds_read_b128 v[40:43], v80 offset:40960
  s_waitcnt lgkmcnt(4)
  v_mfma_f32_16x16x32_bf16 v[24:27], v[64:67], a[44:47], v[24:27]
  buffer_load_dwordx4 a[72:75], v3, s[8:11], s24 offen sc1
  s_add_u32 s24, s24, 262144
  ds_read_b128 v[44:47], v80 offset:41984
  s_waitcnt vmcnt(10) lgkmcnt(4)
  v_mfma_f32_16x16x32_bf16 v[28:31], v[48:51], a[48:51], v[28:31]
  ds_read_b128 v[68:71], v81 offset:51200
  s_waitcnt lgkmcnt(4)
  v_mfma_f32_16x16x32_bf16 v[32:35], v[52:55], a[48:51], v[32:35]
  ds_read_b128 v[72:75], v81 offset:52224
  s_waitcnt lgkmcnt(4)
  v_mfma_f32_16x16x32_bf16 v[36:39], v[56:59], a[48:51], v[36:39]
  s_add_u32 m0, s26, 114688
  s_add_u32 s53, s54, 196608
  buffer_load_dwordx4 v3, s[4:7], s53 offen lds
  s_waitcnt lgkmcnt(3)
  v_mfma_f32_16x16x32_bf16 v[20:23], v[40:43], a[48:51], v[20:23]
  ds_read_b128 v[76:79], v82 offset:51200
  ds_read_b128 v[60:63], v80 offset:51200
  s_waitcnt lgkmcnt(4)
  v_mfma_f32_16x16x32_bf16 v[24:27], v[44:47], a[48:51], v[24:27]
  buffer_load_dwordx4 a[76:79], v3, s[8:11], s24 offen sc1
  s_add_u32 s24, s24, 262144
  ds_read_b128 v[64:67], v80 offset:52224
  s_barrier
  s_waitcnt vmcnt(11) lgkmcnt(4)
  v_mfma_f32_16x16x32_bf16 v[28:31], v[68:71], a[52:55], v[28:31]
  ds_read_b128 v[48:51], v84 offset:0
  s_waitcnt lgkmcnt(4)
  v_mfma_f32_16x16x32_bf16 v[32:35], v[72:75], a[52:55], v[32:35]
  ds_read_b128 v[52:55], v84 offset:1024
  s_waitcnt lgkmcnt(4)
  v_mfma_f32_16x16x32_bf16 v[36:39], v[76:79], a[52:55], v[36:39]
  s_add_u32 m0, s26, 122880
  s_add_u32 s53, s54, 204800
  buffer_load_dwordx4 v3, s[4:7], s53 offen lds
  ds_read_b128 v[56:59], v85 offset:0
  s_waitcnt lgkmcnt(4)
  v_mfma_f32_16x16x32_bf16 v[20:23], v[60:63], a[52:55], v[20:23]
  ds_read_b128 v[40:43], v83 offset:0
  s_waitcnt lgkmcnt(4)
  v_mfma_f32_16x16x32_bf16 v[24:27], v[64:67], a[52:55], v[24:27]
  s_add_u32 m0, s26, 131072
  s_add_u32 s53, s54, 212992
  buffer_load_dwordx4 v3, s[4:7], s53 offen lds
  ds_read_b128 v[44:47], v83 offset:1024
  buffer_load_dwordx4 a[0:3], v3, s[8:11], s24 offen sc1
  s_add_u32 s24, s24, 262144
  s_waitcnt vmcnt(13) lgkmcnt(4)
  v_mfma_f32_16x16x32_bf16 v[28:31], v[48:51], a[56:59], v[28:31]
  ds_read_b128 v[68:71], v84 offset:10240
  s_waitcnt lgkmcnt(4)
  v_mfma_f32_16x16x32_bf16 v[32:35], v[52:55], a[56:59], v[32:35]
  ds_read_b128 v[72:75], v84 offset:11264
  s_waitcnt lgkmcnt(4)
  v_mfma_f32_16x16x32_bf16 v[36:39], v[56:59], a[56:59], v[36:39]
  s_add_u32 m0, s26, 139264
  s_add_u32 s53, s54, 221184
  buffer_load_dwordx4 v3, s[4:7], s53 offen lds
  s_waitcnt lgkmcnt(3)
  v_mfma_f32_16x16x32_bf16 v[20:23], v[40:43], a[56:59], v[20:23]
  ds_read_b128 v[76:79], v85 offset:10240
  ds_read_b128 v[60:63], v83 offset:10240
  s_waitcnt lgkmcnt(4)
  v_mfma_f32_16x16x32_bf16 v[24:27], v[44:47], a[56:59], v[24:27]
  buffer_load_dwordx4 a[4:7], v3, s[8:11], s24 offen sc1
  s_add_u32 s24, s24, 262144
  ds_read_b128 v[64:67], v83 offset:11264
  s_waitcnt vmcnt(10)
  s_barrier
  s_waitcnt lgkmcnt(4)
  v_mfma_f32_16x16x32_bf16 v[28:31], v[68:71], a[60:63], v[28:31]
  ds_read_b128 v[48:51], v84 offset:20480
  s_waitcnt lgkmcnt(4)
  v_mfma_f32_16x16x32_bf16 v[32:35], v[72:75], a[60:63], v[32:35]
  ds_read_b128 v[52:55], v84 offset:21504
  s_waitcnt lgkmcnt(4)
  v_mfma_f32_16x16x32_bf16 v[36:39], v[76:79], a[60:63], v[36:39]
  s_add_u32 m0, s26, 147456
  s_add_u32 s53, s54, 229376
  buffer_load_dwordx4 v3, s[4:7], s53 offen lds
  s_waitcnt lgkmcnt(3)
  v_mfma_f32_16x16x32_bf16 v[20:23], v[60:63], a[60:63], v[20:23]
  ds_read_b128 v[56:59], v85 offset:20480
  ds_read_b128 v[40:43], v83 offset:20480
  s_waitcnt lgkmcnt(4)
  v_mfma_f32_16x16x32_bf16 v[24:27], v[64:67], a[60:63], v[24:27]
  buffer_load_dwordx4 a[8:11], v3, s[8:11], s24 offen sc1
  s_add_u32 s24, s24, 262144
  ds_read_b128 v[44:47], v83 offset:21504
  s_waitcnt lgkmcnt(4)
  v_mfma_f32_16x16x32_bf16 v[28:31], v[48:51], a[64:67], v[28:31]
  ds_read_b128 v[68:71], v84 offset:30720
  s_waitcnt lgkmcnt(4)
  v_mfma_f32_16x16x32_bf16 v[32:35], v[52:55], a[64:67], v[32:35]
  ds_read_b128 v[72:75], v84 offset:31744
  s_waitcnt lgkmcnt(4)
  v_mfma_f32_16x16x32_bf16 v[36:39], v[56:59], a[64:67], v[36:39]
  s_add_u32 m0, s26, 155648
  s_add_u32 s53, s54, 237568
  buffer_load_dwordx4 v3, s[4:7], s53 offen lds
  s_waitcnt lgkmcnt(3)
  v_mfma_f32_16x16x32_bf16 v[20:23], v[40:43], a[64:67], v[20:23]
  ds_read_b128 v[76:79], v85 offset:30720
  ds_read_b128 v[60:63], v83 offset:30720
  s_waitcnt lgkmcnt(4)
  v_mfma_f32_16x16x32_bf16 v[24:27], v[44:47], a[64:67], v[24:27]
  buffer_load_dwordx4 a[12:15], v3, s[8:11], s24 offen sc1
  s_add_u32 s24, s24, 262144
  ds_read_b128 v[64:67], v83 offset:31744
  s_waitcnt vmcnt(10)
  s_barrier
  s_waitcnt lgkmcnt(4)
  v_mfma_f32_16x16x32_bf16 v[28:31], v[68:71], a[68:71], v[28:31]
  ds_read_b128 v[48:51], v84 offset:40960
  s_waitcnt lgkmcnt(4)
  v_mfma_f32_16x16x32_bf16 v[32:35], v[72:75], a[68:71], v[32:35]
  ds_read_b128 v[52:55], v84 offset:41984
  s_waitcnt lgkmcnt(4)
  v_mfma_f32_16x16x32_bf16 v[36:39], v[76:79], a[68:71], v[36:39]
  s_add_u32 m0, s26, 0
  s_add_u32 s53, s54, 245760
  buffer_load_dwordx4 v3, s[4:7], s53 offen lds
  ds_read_b128 v[56:59], v85 offset:40960
  s_waitcnt lgkmcnt(4)
  v_mfma_f32_16x16x32_bf16 v[20:23], v[60:63], a[68:71], v[20:23]
  ds_read_b128 v[40:43], v83 offset:40960
  s_waitcnt lgkmcnt(4)
  v_mfma_f32_16x16x32_bf16 v[24:27], v[64:67], a[68:71], v[24:27]
  s_add_u32 m0, s26, 8192
  s_add_u32 s53, s54, 253952
  buffer_load_dwordx4 v3, s[4:7], s53 offen lds
  ds_read_b128 v[44:47], v83 offset:41984
  buffer_load_dwordx4 a[16:19], v3, s[8:11], s24 offen sc1
  s_add_u32 s24, s24, 262144
  s_waitcnt lgkmcnt(4)
  v_mfma_f32_16x16x32_bf16 v[28:31], v[48:51], a[72:75], v[28:31]
  ds_read_b128 v[68:71], v84 offset:51200
  s_waitcnt lgkmcnt(4)
  v_mfma_f32_16x16x32_bf16 v[32:35], v[52:55], a[72:75], v[32:35]
  ds_read_b128 v[72:75], v84 offset:52224
  s_waitcnt lgkmcnt(4)
  v_mfma_f32_16x16x32_bf16 v[36:39], v[56:59], a[72:75], v[36:39]
  s_add_u32 m0, s26, 16384
  s_add_u32 s53, s54, 262144
  buffer_load_dwordx4 v3, s[4:7], s53 offen lds
  s_waitcnt lgkmcnt(3)
  v_mfma_f32_16x16x32_bf16 v[20:23], v[40:43], a[72:75], v[20:23]
  ds_read_b128 v[76:79], v85 offset:51200
  ds_read_b128 v[60:63], v83 offset:51200
  s_waitcnt lgkmcnt(4)
  v_mfma_f32_16x16x32_bf16 v[24:27], v[44:47], a[72:75], v[24:27]
  buffer_load_dwordx4 a[20:23], v3, s[8:11], s24 offen sc1
  s_add_u32 s24, s24, 262144
  ds_read_b128 v[64:67], v83 offset:52224
  s_waitcnt vmcnt(10)
  s_barrier
  s_waitcnt lgkmcnt(4)
  v_mfma_f32_16x16x32_bf16 v[28:31], v[68:71], a[76:79], v[28:31]
  ds_read_b128 v[48:51], v87 offset:0
  s_waitcnt lgkmcnt(4)
  v_mfma_f32_16x16x32_bf16 v[32:35], v[72:75], a[76:79], v[32:35]
  ds_read_b128 v[52:55], v87 offset:1024
  s_waitcnt lgkmcnt(4)
  v_mfma_f32_16x16x32_bf16 v[36:39], v[76:79], a[76:79], v[36:39]
  s_add_u32 m0, s26, 24576
  s_add_u32 s53, s54, 270336
  buffer_load_dwordx4 v3, s[4:7], s53 offen lds
  s_waitcnt lgkmcnt(3)
  v_mfma_f32_16x16x32_bf16 v[20:23], v[60:63], a[76:79], v[20:23]
  ds_read_b128 v[56:59], v88 offset:0
  ds_read_b128 v[40:43], v86 offset:0
  s_waitcnt lgkmcnt(4)
  v_mfma_f32_16x16x32_bf16 v[24:27], v[64:67], a[76:79], v[24:27]
  buffer_load_dwordx4 a[24:27], v3, s[8:11], s24 offen sc1
  ds_read_b128 v[44:47], v86 offset:1024
  s_waitcnt lgkmcnt(4)
  v_mfma_f32_16x16x32_bf16 v[28:31], v[48:51], a[0:3], v[28:31]
  ds_read_b128 v[68:71], v87 offset:10240
  s_waitcnt lgkmcnt(4)
  v_mfma_f32_16x16x32_bf16 v[32:35], v[52:55], a[0:3], v[32:35]
  ds_read_b128 v[72:75], v87 offset:11264
  s_waitcnt lgkmcnt(4)
  v_mfma_f32_16x16x32_bf16 v[36:39], v[56:59], a[0:3], v[36:39]
  ds_read_b128 v[76:79], v88 offset:10240
  s_waitcnt lgkmcnt(4)
  v_mfma_f32_16x16x32_bf16 v[20:23], v[40:43], a[0:3], v[20:23]
  ds_read_b128 v[60:63], v86 offset:10240
  s_waitcnt lgkmcnt(4)
  v_mfma_f32_16x16x32_bf16 v[24:27], v[44:47], a[0:3], v[24:27]
  ds_read_b128 v[64:67], v86 offset:11264
  s_waitcnt vmcnt(8)
  s_barrier
  s_waitcnt lgkmcnt(4)
  v_mfma_f32_16x16x32_bf16 v[28:31], v[68:71], a[4:7], v[28:31]
  ds_read_b128 v[48:51], v87 offset:20480
  s_waitcnt lgkmcnt(4)
  v_mfma_f32_16x16x32_bf16 v[32:35], v[72:75], a[4:7], v[32:35]
  ds_read_b128 v[52:55], v87 offset:21504
  s_waitcnt lgkmcnt(4)
  v_mfma_f32_16x16x32_bf16 v[36:39], v[76:79], a[4:7], v[36:39]
  ds_read_b128 v[56:59], v88 offset:20480
  s_waitcnt lgkmcnt(4)
  v_mfma_f32_16x16x32_bf16 v[20:23], v[60:63], a[4:7], v[20:23]
  ds_read_b128 v[40:43], v86 offset:20480
  s_waitcnt lgkmcnt(4)
  v_mfma_f32_16x16x32_bf16 v[24:27], v[64:67], a[4:7], v[24:27]
  ds_read_b128 v[44:47], v86 offset:21504
  s_waitcnt lgkmcnt(4)
  v_mfma_f32_16x16x32_bf16 v[28:31], v[48:51], a[8:11], v[28:31]
  ds_read_b128 v[68:71], v87 offset:30720
  s_waitcnt lgkmcnt(4)
  v_mfma_f32_16x16x32_bf16 v[32:35], v[52:55], a[8:11], v[32:35]
  ds_read_b128 v[72:75], v87 offset:31744
  s_waitcnt lgkmcnt(4)
  v_mfma_f32_16x16x32_bf16 v[36:39], v[56:59], a[8:11], v[36:39]
  ds_read_b128 v[76:79], v88 offset:30720
  s_waitcnt lgkmcnt(4)
  v_mfma_f32_16x16x32_bf16 v[20:23], v[40:43], a[8:11], v[20:23]
  ds_read_b128 v[60:63], v86 offset:30720
  s_waitcnt lgkmcnt(4)
  v_mfma_f32_16x16x32_bf16 v[24:27], v[44:47], a[8:11], v[24:27]
  ds_read_b128 v[64:67], v86 offset:31744
  s_waitcnt vmcnt(3)
  s_barrier
  s_waitcnt lgkmcnt(4)
  v_mfma_f32_16x16x32_bf16 v[28:31], v[68:71], a[12:15], v[28:31]
  ds_read_b128 v[48:51], v81 offset:0
  s_waitcnt lgkmcnt(4)
  v_mfma_f32_16x16x32_bf16 v[32:35], v[72:75], a[12:15], v[32:35]
  ds_read_b128 v[52:55], v81 offset:1024
  s_waitcnt lgkmcnt(4)
  v_mfma_f32_16x16x32_bf16 v[36:39], v[76:79], a[12:15], v[36:39]
  ds_read_b128 v[56:59], v82 offset:0
  s_waitcnt lgkmcnt(4)
  v_mfma_f32_16x16x32_bf16 v[20:23], v[60:63], a[12:15], v[20:23]
  ds_read_b128 v[40:43], v80 offset:0
  s_waitcnt lgkmcnt(4)
  v_mfma_f32_16x16x32_bf16 v[24:27], v[64:67], a[12:15], v[24:27]
  ds_read_b128 v[44:47], v80 offset:1024
  s_waitcnt lgkmcnt(4)
  v_mfma_f32_16x16x32_bf16 v[28:31], v[48:51], a[16:19], v[28:31]
  ds_read_b128 v[68:71], v81 offset:10240
  s_waitcnt lgkmcnt(4)
  v_mfma_f32_16x16x32_bf16 v[32:35], v[52:55], a[16:19], v[32:35]
  ds_read_b128 v[72:75], v81 offset:11264
  s_waitcnt lgkmcnt(4)
  v_mfma_f32_16x16x32_bf16 v[36:39], v[56:59], a[16:19], v[36:39]
  ds_read_b128 v[76:79], v82 offset:10240
  s_waitcnt lgkmcnt(4)
  v_mfma_f32_16x16x32_bf16 v[20:23], v[40:43], a[16:19], v[20:23]
  ds_read_b128 v[60:63], v80 offset:10240
  s_waitcnt lgkmcnt(4)
  v_mfma_f32_16x16x32_bf16 v[24:27], v[44:47], a[16:19], v[24:27]
  ds_read_b128 v[64:67], v80 offset:11264
  s_waitcnt vmcnt(1)
  s_barrier
  s_waitcnt lgkmcnt(4)
  v_mfma_f32_16x16x32_bf16 v[28:31], v[68:71], a[20:23], v[28:31]
  ds_read_b128 v[48:51], v81 offset:20480
  s_waitcnt lgkmcnt(4)
  v_mfma_f32_16x16x32_bf16 v[32:35], v[72:75], a[20:23], v[32:35]
  ds_read_b128 v[52:55], v81 offset:21504
  s_waitcnt lgkmcnt(4)
  v_mfma_f32_16x16x32_bf16 v[36:39], v[76:79], a[20:23], v[36:39]
  ds_read_b128 v[56:59], v82 offset:20480
  s_waitcnt lgkmcnt(4)
  v_mfma_f32_16x16x32_bf16 v[20:23], v[60:63], a[20:23], v[20:23]
  ds_read_b128 v[40:43], v80 offset:20480
  s_waitcnt lgkmcnt(4)
  v_mfma_f32_16x16x32_bf16 v[24:27], v[64:67], a[20:23], v[24:27]
  ds_read_b128 v[44:47], v80 offset:21504
  s_waitcnt vmcnt(0) lgkmcnt(4)
  v_mfma_f32_16x16x32_bf16 v[28:31], v[48:51], a[24:27], v[28:31]
  s_waitcnt lgkmcnt(3)
  v_mfma_f32_16x16x32_bf16 v[32:35], v[52:55], a[24:27], v[32:35]
  s_waitcnt lgkmcnt(2)
  v_mfma_f32_16x16x32_bf16 v[36:39], v[56:59], a[24:27], v[36:39]
  s_waitcnt lgkmcnt(1)
  v_mfma_f32_16x16x32_bf16 v[20:23], v[40:43], a[24:27], v[20:23]
  s_waitcnt lgkmcnt(0)
  v_mfma_f32_16x16x32_bf16 v[24:27], v[44:47], a[24:27], v[24:27]
  s_mul_i32 s37, s20, 3072
  s_xor_b32 s38, s20, 4
  s_mul_i32 s38, s38, 3072
  s_add_u32 s37, s37, 122880
  s_add_u32 s38, s38, 122880
  v_add_u32 v80, s37, v3
  v_add_u32 v81, s38, v3
  ds_write_b128 v80, v[28:31] offset:0
  ds_write_b128 v80, v[32:35] offset:1024
  ds_write_b128 v80, v[36:39] offset:2048
  v_add_f32 v20, v20, v8
  v_add_f32 v24, v24, v9
  v_add_f32 v21, v21, v10
  v_add_f32 v25, v25, v11
  v_add_f32 v22, v22, v12
  v_add_f32 v26, v26, v13
  v_add_f32 v23, v23, v14
  v_add_f32 v27, v27, v15
  v_add_f32 v36, v36, v16
  v_add_f32 v37, v37, v17
  v_add_f32 v38, v38, v18
  v_add_f32 v39, v39, v19
  s_mov_b32 s12, s40
  s_mov_b32 s13, s41
  s_mov_b32 s14, 0x280000
  s_mov_b32 s15, 0x00020000
  v_mul_u32_u24 v5, 1280, v1
  v_lshl_add_u32 v4, v2, 4, v5
  v_lshl_add_u32 v6, v2, 3, v5
  s_mul_i32 s37, s23, 20
  s_lshl_b32 s32, s27, 6
  s_add_u32 s32, s32, s37
  s_lshl_b32 s34, s28, 6
  s_add_u32 s34, s34, s37
  s_add_u32 s34, s34, s29
  s_add_u32 s34, s34, s33
  s_waitcnt lgkmcnt(0)
  s_barrier
  ds_read_b128 v[40:43], v81 offset:0
  ds_read_b128 v[44:47], v81 offset:1024
  ds_read_b128 v[48:51], v81 offset:2048
  s_waitcnt lgkmcnt(2)
  v_add_f32 v20, v20, v40
  v_add_f32 v21, v21, v41
  v_add_f32 v22, v22, v42
  v_add_f32 v23, v23, v43
  s_waitcnt lgkmcnt(1)
  v_add_f32 v24, v24, v44
  v_add_f32 v25, v25, v45
  v_add_f32 v26, v26, v46
  v_add_f32 v27, v27, v47
  v_cvt_pk_bf16_f32 v60, v20, v24
  v_cvt_pk_bf16_f32 v61, v21, v25
  v_cvt_pk_bf16_f32 v62, v22, v26
  v_cvt_pk_bf16_f32 v63, v23, v27
  buffer_store_dwordx4 v[60:63], v4, s[12:15], s32 offen
  s_waitcnt lgkmcnt(0)
  v_add_f32 v36, v36, v48
  v_add_f32 v37, v37, v49
  v_add_f32 v38, v38, v50
  v_add_f32 v39, v39, v51
  v_cvt_pk_bf16_f32 v64, v36, v37
  v_cvt_pk_bf16_f32 v65, v38, v39
  buffer_store_dwordx2 v[64:65], v6, s[12:15], s34 offen
  s_endpgm
.Lkf_kernel_other2:
  s_endpgm

.section .rodata,"a"
.p2align 6
.amdhsa_kernel k1_kernel
  .amdhsa_next_free_vgpr 122
  .amdhsa_next_free_sgpr 102
  .amdhsa_accum_offset 124
  .amdhsa_group_segment_fixed_size 0
  .amdhsa_kernarg_size 88
  .amdhsa_user_sgpr_count 2
  .amdhsa_user_sgpr_kernarg_segment_ptr 1
  .amdhsa_system_sgpr_workgroup_id_x 1
.end_amdhsa_kernel

.p2align 6
.amdhsa_kernel k2_kernel
  .amdhsa_next_free_vgpr 160
  .amdhsa_next_free_sgpr 102
  .amdhsa_accum_offset 160
  .amdhsa_group_segment_fixed_size 0
  .amdhsa_kernarg_size 88
  .amdhsa_user_sgpr_count 2
  .amdhsa_user_sgpr_kernarg_segment_ptr 1
  .amdhsa_system_sgpr_workgroup_id_x 1
.end_amdhsa_kernel

.p2align 6
.amdhsa_kernel kf_kernel
  .amdhsa_next_free_vgpr 244
  .amdhsa_next_free_sgpr 102
  .amdhsa_accum_offset 164
  .amdhsa_group_segment_fixed_size 0
  .amdhsa_kernarg_size 88
  .amdhsa_user_sgpr_count 2
  .amdhsa_user_sgpr_kernarg_segment_ptr 1
  .amdhsa_system_sgpr_workgroup_id_x 1
.end_amdhsa_kernel
```
